```python
import torch

def _softmax(x, axis=-1):
    return torch.softmax(x, dim=axis)
def _gelu(x):
    return torch.nn.functional.gelu(x, approximate="tanh")
def _silu(x):
    return torch.nn.functional.silu(x)
def _sigmoid(x):
    return torch.sigmoid(x)
def _layernorm(x, axis=-1, eps=1e-5):
    m = x.mean(dim=axis, keepdim=True)
    v = x.var(dim=axis, keepdim=True, unbiased=False)
    return (x - m) / torch.sqrt(v + eps)
def _scatter_add(tgt, idx, src, axis=0):
    return tgt.clone().index_add_(axis, idx, src)
def _segment_sum(src, seg, n):
    out = torch.zeros((n,) + src.shape[1:], dtype=src.dtype)
    return out.index_add_(0, seg, src)
def _pad(x, pw):
    flat = tuple(v for pair in reversed(pw) for v in pair)
    return torch.nn.functional.pad(x, flat)

kernel_name = 'concat_heads__mha_block__sliding_local_dilated__prompt'

def setup_inputs():

    _w = (lambda a: (lambda t: t.to(torch.bfloat16) if t.is_floating_point() else t)(torch.as_tensor(a)))
    def _A_setup():
        B, S, D, H = 1, 2048, 1024, 32
        return {
            "x": _w((lambda *s: torch.randn(*s, dtype=torch.bfloat16) * 0.1)(B, S, D)),
            "wqkv": _w((lambda *s: torch.randn(*s, dtype=torch.bfloat16) * 0.4)(D, 3 * D)),
            "wo": _w((lambda *s: torch.randn(*s, dtype=torch.bfloat16) * 0.8)(D, D)),
        }
    _A_in = _A_setup()

    def _B_setup():
        B, S, D = 1, 2048, 1024
        return {
            "x": _w((lambda *s: torch.randn(*s, dtype=torch.bfloat16) * 0.1)(B, S, D)),
            "wqkv": _w((lambda *s: torch.randn(*s, dtype=torch.bfloat16) * 0.4)(D, 3 * D)),
            "wo": _w((lambda *s: torch.randn(*s, dtype=torch.bfloat16) * 0.8)(D, D)),
        }
    _B_in = _B_setup()

    return {
        "A_x": _A_in["x"],
        "A_wqkv": _A_in["wqkv"],
        "A_wo": _A_in["wo"],
        "B_x": _B_in["x"],
        "B_wqkv": _B_in["wqkv"],
        "B_wo": _B_in["wo"],
    }

def reference(A_x, A_wqkv, A_wo, B_x, B_wqkv, B_wo):
    def _A_ref(x, wqkv, wo):
        B, S, D = x.shape
        H = 32
        Dh = D // H
        qkv = (lambda x, *d: x.permute(*d))((x @ wqkv).reshape(B, S, 3, H, Dh), 2, 0, 3, 1, 4)
        q, k, v = qkv[0], qkv[1], qkv[2]
        scores = torch.einsum("bhqd,bhkd->bhqk", q, k) * (Dh ** -0.5)
        p = _softmax(scores, axis=-1)
        o = torch.einsum("bhqk,bhkd->bhqd", p, v)
        return (lambda x, *d: x.permute(*d))(o, 0, 2, 1, 3).reshape(B, S, D) @ wo

    def _B_ref(x, wqkv, wo):
        B, S, D = x.shape
        H = 32; Dh = D // H
        W, dil = 8, 2
        qkv = (lambda x, *d: x.permute(*d))((x @ wqkv).reshape(B, S, 3, H, Dh), 2, 0, 3, 1, 4)
        q, k, v = qkv[0], qkv[1], qkv[2]
        scale = Dh ** -0.5
        pos = torch.arange(S)
        off = torch.arange(W) * dil
        idx = pos[:, None] - off[None, :]
        mask = idx >= 0
        idx_c = torch.where(mask, idx, 0).reshape(-1)
        kg = k[:, :, idx_c, :].reshape(B, H, S, W, Dh)
        vg = v[:, :, idx_c, :].reshape(B, H, S, W, Dh)
        logits = torch.einsum("bhsd,bhswd->bhsw", q, kg) * scale
        logits = torch.where(mask[None, None, :, :], logits, -1e9)
        attn = _softmax(logits, axis=-1)
        o = torch.einsum("bhsw,bhswd->bhsd", attn, vg)
        return (lambda x, *d: x.permute(*d))(o, 0, 2, 1, 3).reshape(B, S, D) @ wo

    a = _A_ref(A_x, A_wqkv, A_wo)
    b = _B_ref(B_x, B_wqkv, B_wo)
    return torch.concatenate([a, b], axis=-1)
```

```asm
; @launch grid=(256,1,1) block=(640,1,1) lds=163840
.amdgcn_target "amdgcn-amd-amdhsa--gfx950"
.text
.globl concat_heads__mha_block__sliding_local_dilated__prompt_kernel
.p2align 8
.type concat_heads__mha_block__sliding_local_dilated__prompt_kernel,@function
concat_heads__mha_block__sliding_local_dilated__prompt_kernel:
    s_load_dwordx16 s[76:91], s[0:1], 0
    s_load_dwordx2 s[92:93], s[0:1], 64
    v_lshrrev_b32 v14, 6, v0
    v_and_b32 v1, 63, v0
    v_readfirstlane_b32 s19, v14
    s_cmp_ge_u32 s2, 256
    s_cbranch_scc1 L_done
    s_and_b32 s34, s2, 7
    s_lshr_b32 s35, s2, 3
    s_lshr_b32 s16, s35, 4
    s_and_b32 s17, s34, 1
    s_lshl_b32 s17, s17, 2
    s_and_b32 s36, s35, 3
    s_add_u32 s17, s17, s36
    s_lshr_b32 s18, s34, 1
    s_lshl_b32 s18, s18, 2
    s_lshr_b32 s36, s35, 2
    s_and_b32 s36, s36, 3
    s_add_u32 s18, s18, s36
    s_mov_b32 s14, 33619968
    s_mov_b32 s15, 0x20000
    s_mov_b32 s74, 256
    s_mov_b32 s75, 0x20000
    s_mov_b32 s7, 0x20000
    s_mov_b32 s11, 0x20000
    s_cmp_lt_u32 s19, 8
    s_cbranch_scc1 P1_compute
    s_setprio 3
    s_mul_i32 s49, s16, 1024
    s_add_u32 s48, s17, s18
    s_and_b32 s48, s48, 1
    v_lshrrev_b32 v15, 3, v1
    v_lshrrev_b32 v16, 4, v1
    v_and_b32 v18, 7, v1
    s_mov_b32 s40, 0
    s_cmp_eq_u32 s19, 8
    s_cbranch_scc1 P1_xload
    s_lshl_b32 s39, s18, 7
    s_sub_u32 s6, 6291456, s39
    v_and_b32 v16, 1, v16
    v_lshlrev_b32 v16, 1, v16
    v_xor_b32 v16, v18, v16
    v_lshlrev_b32 v16, 4, v16
    v_mul_u32_u24 v17, 6144, v15
    v_add_u32 v2, v17, v16
    v_xor_b32 v16, 64, v16
    v_add_u32 v3, v17, v16
    v_add_u32 v3, 48128, v3
    v_add_u32 v4, 96256, v2
    v_add_u32 v5, 96256, v3
    s_lshl_b32 s48, s48, 1
    s_bfe_u32 s23, s17, 0x10001
    s_or_b32 s48, s48, s23
    s_mov_b32 s22, 98304
    v_lshlrev_b32 v20, 2, v1
    v_mov_b32 v21, 0
    v_mov_b32 v22, 1
    s_lshl_b32 s45, s2, 8
    s_add_u32 s45, s45, 33554432
    s_and_b32 s44, s35, 7
    s_lshl_b32 s44, s44, 1
    s_add_u32 s44, s44, 9
    s_cmp_eq_u32 s16, 0
    s_waitcnt lgkmcnt(0)
    s_cselect_b32 s4, s78, s84
    s_cselect_b32 s5, s79, s85
    s_add_u32 s4, s4, s39
    s_addc_u32 s5, s5, 0
    s_mov_b32 s12, s92
    s_mov_b32 s13, s93
    s_mov_b32 s72, s90
    s_mov_b32 s73, s91
    s_branch P1_wgo
P1_wclr:
    buffer_store_dword v21, v20, s[12:15], s45 offen sc1
P1_wwait:
    s_waitcnt vmcnt(12)
    s_barrier
    s_cmp_eq_u32 s40, s44
    s_cbranch_scc0 P1_wgo
    s_waitcnt vmcnt(0)
    s_mov_b64 exec, 1
    buffer_atomic_add v22, off, s[72:75], 0 sc1
    s_mov_b64 exec, -1
P1_wgo:
    s_xor_b32 s23, s40, s48
    s_lshl_b32 s23, s23, 6
    s_add_u32 s23, s23, s49
    s_and_b32 s23, s23, 2047
    s_mul_i32 s20, s23, 3072
    s_add_u32 m0, s22, 0
    s_add_u32 s40, s40, 1
    buffer_load_dwordx4 v2, s[4:7], s20 offen offset:0 lds
    buffer_load_dwordx4 v3, s[4:7], s20 offen offset:1024 lds
    buffer_load_dwordx4 v4, s[4:7], s20 offen offset:2048 lds
    buffer_load_dwordx4 v5, s[4:7], s20 offen offset:3072 lds
    s_add_u32 m0, s22, 4096
    s_add_u32 s20, s20, 2048
    buffer_load_dwordx4 v2, s[4:7], s20 offen offset:0 lds
    buffer_load_dwordx4 v3, s[4:7], s20 offen offset:1024 lds
    buffer_load_dwordx4 v4, s[4:7], s20 offen offset:2048 lds
    buffer_load_dwordx4 v5, s[4:7], s20 offen offset:3072 lds
    s_add_u32 m0, s22, 8192
    s_add_u32 s20, s20, 2048
    buffer_load_dwordx4 v2, s[4:7], s20 offen offset:0 lds
    buffer_load_dwordx4 v3, s[4:7], s20 offen offset:1024 lds
    buffer_load_dwordx4 v4, s[4:7], s20 offen offset:2048 lds
    buffer_load_dwordx4 v5, s[4:7], s20 offen offset:3072 lds
    s_add_u32 s22, s22, 12288
    s_cmp_eq_u32 s22, 159744
    s_cselect_b32 s22, 98304, s22
    s_cmp_eq_u32 s40, 3
    s_cbranch_scc0 P1_w1
    s_waitcnt vmcnt(12)
    s_barrier
P1_w1:
    s_cmp_lt_u32 s40, 5
    s_cbranch_scc1 P1_wgo
    s_bitcmp0_b32 s40, 0
    s_cbranch_scc1 P1_w2
    s_cmp_eq_u32 s40, 5
    s_cbranch_scc1 P1_wclr
    s_branch P1_wwait
P1_w2:
    s_cmp_lt_u32 s40, 32
    s_cbranch_scc1 P1_wgo
    s_branch P1_ltail
P1_xload:
    s_mov_b32 s6, 0x80000
    s_lshl_b32 s36, s17, 19
    v_xor_b32 v17, v18, v16
    v_lshlrev_b32 v17, 4, v17
    v_lshl_add_u32 v2, v15, 11, v17
    v_xor_b32 v3, 64, v2
    v_add_u32 v3, 15360, v3
    v_add_u32 v4, 30720, v2
    v_add_u32 v5, 30720, v3
    s_mov_b32 s22, 0
    s_cmp_eq_u32 s16, 0
    s_waitcnt lgkmcnt(0)
    s_cselect_b32 s4, s76, s82
    s_cselect_b32 s5, s77, s83
    s_add_u32 s4, s4, s36
    s_addc_u32 s5, s5, 0
P1_xgo:
    s_xor_b32 s21, s40, s48
    s_lshl_b32 s21, s21, 7
    s_add_u32 s21, s21, s49
    s_and_b32 s21, s21, 2047
    s_add_u32 m0, s22, 0
    s_add_u32 s20, s21, 0
    buffer_load_dwordx4 v2, s[4:7], s20 offen offset:0 lds
    buffer_load_dwordx4 v3, s[4:7], s20 offen offset:1024 lds
    buffer_load_dwordx4 v4, s[4:7], s20 offen offset:2048 lds
    buffer_load_dwordx4 v5, s[4:7], s20 offen offset:3072 lds
    s_add_u32 m0, s22, 4096
    s_add_u32 s20, s21, 65536
    buffer_load_dwordx4 v2, s[4:7], s20 offen offset:0 lds
    buffer_load_dwordx4 v3, s[4:7], s20 offen offset:1024 lds
    buffer_load_dwordx4 v4, s[4:7], s20 offen offset:2048 lds
    buffer_load_dwordx4 v5, s[4:7], s20 offen offset:3072 lds
    s_add_u32 m0, s22, 8192
    s_add_u32 s20, s21, 131072
    buffer_load_dwordx4 v2, s[4:7], s20 offen offset:0 lds
    buffer_load_dwordx4 v3, s[4:7], s20 offen offset:1024 lds
    buffer_load_dwordx4 v4, s[4:7], s20 offen offset:2048 lds
    buffer_load_dwordx4 v5, s[4:7], s20 offen offset:3072 lds
    s_add_u32 m0, s22, 12288
    s_add_u32 s20, s21, 196608
    buffer_load_dwordx4 v2, s[4:7], s20 offen offset:0 lds
    buffer_load_dwordx4 v3, s[4:7], s20 offen offset:1024 lds
    buffer_load_dwordx4 v4, s[4:7], s20 offen offset:2048 lds
    buffer_load_dwordx4 v5, s[4:7], s20 offen offset:3072 lds
    s_add_u32 m0, s22, 16384
    s_add_u32 s20, s21, 262144
    s_cmp_eq_u32 s40, 1
    s_cbranch_scc0 P1_x0
    s_waitcnt vmcnt(16)
    s_barrier
P1_x0:
    buffer_load_dwordx4 v2, s[4:7], s20 offen offset:0 lds
    buffer_load_dwordx4 v3, s[4:7], s20 offen offset:1024 lds
    buffer_load_dwordx4 v4, s[4:7], s20 offen offset:2048 lds
    buffer_load_dwordx4 v5, s[4:7], s20 offen offset:3072 lds
    s_add_u32 m0, s22, 20480
    s_add_u32 s20, s21, 327680
    buffer_load_dwordx4 v2, s[4:7], s20 offen offset:0 lds
    buffer_load_dwordx4 v3, s[4:7], s20 offen offset:1024 lds
    buffer_load_dwordx4 v4, s[4:7], s20 offen offset:2048 lds
    buffer_load_dwordx4 v5, s[4:7], s20 offen offset:3072 lds
    s_add_u32 m0, s22, 24576
    s_add_u32 s20, s21, 393216
    buffer_load_dwordx4 v2, s[4:7], s20 offen offset:0 lds
    buffer_load_dwordx4 v3, s[4:7], s20 offen offset:1024 lds
    buffer_load_dwordx4 v4, s[4:7], s20 offen offset:2048 lds
    buffer_load_dwordx4 v5, s[4:7], s20 offen offset:3072 lds
    s_add_u32 m0, s22, 28672
    s_add_u32 s20, s21, 458752
    buffer_load_dwordx4 v2, s[4:7], s20 offen offset:0 lds
    buffer_load_dwordx4 v3, s[4:7], s20 offen offset:1024 lds
    buffer_load_dwordx4 v4, s[4:7], s20 offen offset:2048 lds
    buffer_load_dwordx4 v5, s[4:7], s20 offen offset:3072 lds
P1_xskip:
    s_add_u32 s22, s22, 32768
    s_cmp_eq_u32 s22, 98304
    s_cselect_b32 s22, 0, s22
    s_add_u32 s40, s40, 1
    s_cmp_lt_u32 s40, 3
    s_cbranch_scc1 P1_xgo
    s_waitcnt vmcnt(32)
    s_barrier
    s_cmp_lt_u32 s40, 16
    s_cbranch_scc1 P1_xgo
P1_ltail:
    s_mov_b32 s12, s92
    s_mov_b32 s13, s93
    s_mov_b32 s72, s90
    s_mov_b32 s73, s91
    buffer_load_dword v23, off, s[72:75], 0
    s_waitcnt vmcnt(0)
    s_barrier
    v_and_b32 v10, 8, v1
    v_lshlrev_b32 v10, 4, v10
    v_and_b32 v11, 3, v1
    v_lshl_add_u32 v10, v11, 3, v10
    v_bfe_u32 v11, v1, 2, 1
    s_and_b32 s45, s2, 0x66
    v_add3_u32 v10, v10, v11, s45
    s_lshl_b32 s45, s17, 2
    s_add_u32 s45, s45, 33554432
    v_lshlrev_b32 v10, 8, v10
    v_add_u32 v10, s45, v10
    v_lshrrev_b32 v13, 3, v1
    v_and_b32 v13, 1, v13
    s_lshl_b32 s40, s17, 1
    v_add_u32 v13, s40, v13
    v_lshrrev_b32 v12, 3, v13
    v_and_b32 v13, 7, v13
    v_lshl_add_u32 v12, v13, 3, v12
    v_and_b32 v13, 3, v1
    v_lshl_add_u32 v12, v13, 6, v12
    v_and_b32 v13, 4, v1
    v_lshrrev_b32 v13, 1, v13
    v_add3_u32 v12, v12, v13, 4
    v_lshlrev_b32 v12, 8, v12
    v_lshrrev_b32 v13, 4, v1
    v_and_b32 v13, 1, v13
    v_lshl_add_u32 v12, v13, 2, v12
    s_lshl_b32 s45, s18, 3
    s_add_u32 s45, s45, 33554560
    v_add_u32 v12, s45, v12
    s_mov_b32 s33, s16
    s_mov_b32 s30, s17
    s_mov_b32 s31, s18
    s_barrier
    s_branch P2_helpers
P1_compute:
    s_getpc_b64 s[40:41]
    v_lshlrev_b32 v20, 7, v0
    v_min_u32 v20, L_done-P1_compute-64, v20
    s_cmp_lt_u32 s19, 3
    s_cbranch_scc0 P1_nopf
    global_load_dword v21, v20, s[40:41]
P1_nopf:
    v_lshrrev_b32 v15, 1, v14
    v_and_b32 v16, 15, v1
    v_lshl_add_u32 v17, v15, 6, v16
    v_lshlrev_b32 v17, 7, v17
    v_lshrrev_b32 v16, 1, v16
    v_lshrrev_b32 v18, 4, v1
    v_xor_b32 v16, v16, v18
    v_lshl_add_u32 v2, v16, 4, v17
    s_and_b32 s36, s17, 2
    s_lshl_b32 s36, s36, 5
    v_xor_b32 v2, s36, v2
    v_xor_b32 v3, 64, v2
    v_lshrrev_b32 v16, 2, v1
    v_and_b32 v16, 3, v16
    v_lshl_add_u32 v17, v18, 3, v16
    v_lshlrev_b32 v17, 7, v17
    v_lshrrev_b32 v16, 1, v16
    v_and_b32 v19, 1, v18
    v_lshl_add_u32 v16, v19, 1, v16
    v_and_b32 v19, 1, v14
    v_lshlrev_b32 v19, 1, v19
    v_xor_b32 v16, v16, v19
    v_lshl_add_u32 v17, v16, 5, v17
    v_and_b32 v16, 3, v1
    v_lshl_add_u32 v4, v16, 3, v17
    v_xor_b32 v5, 32, v4
    v_lshlrev_b32 v1, 4, v1
    v_mov_b64 v[72:73], 0
    v_mov_b64 v[74:75], 0
    v_mov_b64 v[76:77], 0
    v_mov_b64 v[78:79], 0
    v_mov_b64 v[80:81], 0
    v_mov_b64 v[82:83], 0
    v_mov_b64 v[84:85], 0
    v_mov_b64 v[86:87], 0
    v_mov_b64 v[88:89], 0
    v_mov_b64 v[90:91], 0
    v_mov_b64 v[92:93], 0
    v_mov_b64 v[94:95], 0
    v_mov_b64 v[96:97], 0
    v_mov_b64 v[98:99], 0
    v_mov_b64 v[100:101], 0
    v_mov_b64 v[102:103], 0
    v_mov_b64 v[104:105], 0
    v_mov_b64 v[106:107], 0
    v_mov_b64 v[108:109], 0
    v_mov_b64 v[110:111], 0
    v_mov_b64 v[112:113], 0
    v_mov_b64 v[114:115], 0
    v_mov_b64 v[116:117], 0
    v_mov_b64 v[118:119], 0
    v_mov_b64 v[120:121], 0
    v_mov_b64 v[122:123], 0
    v_mov_b64 v[124:125], 0
    v_mov_b64 v[126:127], 0
    v_mov_b64 v[128:129], 0
    v_mov_b64 v[130:131], 0
    v_mov_b64 v[132:133], 0
    v_mov_b64 v[134:135], 0
    v_mov_b64 v[136:137], 0
    v_mov_b64 v[138:139], 0
    v_mov_b64 v[140:141], 0
    v_mov_b64 v[142:143], 0
    v_mov_b64 v[144:145], 0
    v_mov_b64 v[146:147], 0
    v_mov_b64 v[148:149], 0
    v_mov_b64 v[150:151], 0
    v_mov_b64 v[152:153], 0
    v_mov_b64 v[154:155], 0
    v_mov_b64 v[156:157], 0
    v_mov_b64 v[158:159], 0
    v_mov_b64 v[160:161], 0
    v_mov_b64 v[162:163], 0
    v_mov_b64 v[164:165], 0
    v_mov_b64 v[166:167], 0
    s_and_b32 s36, s19, 1
    s_lshl_b32 s37, s18, 1
    s_add_u32 s36, s36, s37
    s_lshl_b32 s36, s36, 6
    s_lshl_b32 s37, s17, 3
    s_add_u32 s36, s36, s37
    s_lshr_b32 s37, s19, 1
    s_lshl_b32 s37, s37, 1
    s_add_u32 s36, s36, s37
    s_lshl_b32 s64, s36, 11
    s_add_u32 s65, s64, 2048
    s_lshl_b32 s66, s36, 12
    s_add_u32 s66, s66, 4194304
    s_add_u32 s67, s66, 4096
    s_add_u32 s68, s66, 2048
    s_add_u32 s69, s66, 6144
    s_mov_b32 s42, 1048744942
    s_mov_b32 s43, 1048744942
    s_mov_b32 s44, 0
    s_mov_b32 s46, 98304
    s_mov_b32 s40, 16
    v_mov_b32 v0, v2
    v_add_u32 v6, s46, v4
    v_add_u32 v7, s46, v5
    s_waitcnt lgkmcnt(0)
    s_mov_b32 s12, s92
    s_mov_b32 s13, s93
    s_mov_b32 s72, s90
    s_mov_b32 s73, s91
    s_waitcnt vmcnt(0)
    s_barrier
    ds_read_b64_tr_b16 v[24:25], v6 offset:0
    ds_read_b128 v[8:11], v0 offset:0
    ds_read_b64_tr_b16 v[26:27], v6 offset:512
    ds_read_b64_tr_b16 v[28:29], v7 offset:0
    ds_read_b64_tr_b16 v[30:31], v7 offset:512
    ds_read_b64_tr_b16 v[32:33], v6 offset:4096
    ds_read_b64_tr_b16 v[34:35], v6 offset:4608
    ds_read_b128 v[12:15], v0 offset:2048
    ds_read_b64_tr_b16 v[36:37], v7 offset:4096
    ds_read_b64_tr_b16 v[38:39], v7 offset:4608
    ds_read_b64_tr_b16 v[40:41], v6 offset:8192
    ds_read_b64_tr_b16 v[42:43], v6 offset:8704
    ds_read_b64_tr_b16 v[44:45], v7 offset:8192
    ds_read_b128 v[16:19], v0 offset:4096
    ds_read_b64_tr_b16 v[46:47], v7 offset:8704
    ds_read_b128 v[20:23], v0 offset:6144
    s_add_u32 s46, s46, 12288
    s_cmp_eq_u32 s46, 159744
    s_cselect_b32 s46, 98304, s46
    v_add_u32 v6, s46, v4
    v_add_u32 v7, s46, v5
    v_mov_b32 v1, v3
.p2align 6
P1_loop:
    s_waitcnt lgkmcnt(1)
    v_mfma_f32_16x16x32_bf16 v[72:75], v[24:27], v[8:11], v[72:75]
    ds_read_b64_tr_b16 v[48:49], v6 offset:0
    v_mfma_f32_16x16x32_bf16 v[76:79], v[28:31], v[8:11], v[76:79]
    ds_read_b64_tr_b16 v[50:51], v6 offset:512
    v_mfma_f32_16x16x32_bf16 v[80:83], v[32:35], v[8:11], v[80:83]
    ds_read_b64_tr_b16 v[52:53], v7 offset:0
    v_mfma_f32_16x16x32_bf16 v[84:87], v[36:39], v[8:11], v[84:87]
    ds_read_b64_tr_b16 v[54:55], v7 offset:512
    v_mfma_f32_16x16x32_bf16 v[88:91], v[8:11], v[40:43], v[88:91]
    ds_read_b64_tr_b16 v[56:57], v6 offset:4096
    v_mfma_f32_16x16x32_bf16 v[92:95], v[8:11], v[44:47], v[92:95]
    ds_read_b128 v[8:11], v1 offset:0
    v_mfma_f32_16x16x32_bf16 v[116:119], v[12:15], v[44:47], v[116:119]
    ds_read_b64_tr_b16 v[58:59], v6 offset:4608
    s_add_u32 s44, s44, 32768
    v_mfma_f32_16x16x32_bf16 v[112:115], v[12:15], v[40:43], v[112:115]
    ds_read_b64_tr_b16 v[60:61], v7 offset:4096
    s_cmp_eq_u32 s44, 98304
    v_mfma_f32_16x16x32_bf16 v[108:111], v[36:39], v[12:15], v[108:111]
    ds_read_b64_tr_b16 v[62:63], v7 offset:4608
    s_cselect_b32 s44, 0, s44
    v_mfma_f32_16x16x32_bf16 v[104:107], v[32:35], v[12:15], v[104:107]
    ds_read_b64_tr_b16 v[64:65], v6 offset:8192
    v_add_u32 v0, s44, v2
    v_mfma_f32_16x16x32_bf16 v[100:103], v[28:31], v[12:15], v[100:103]
    ds_read_b64_tr_b16 v[66:67], v6 offset:8704
    s_add_u32 s46, s46, 12288
    v_mfma_f32_16x16x32_bf16 v[96:99], v[24:27], v[12:15], v[96:99]
    ds_read_b128 v[12:15], v1 offset:2048
    s_cmp_eq_u32 s46, 159744
    v_mfma_f32_16x16x32_bf16 v[120:123], v[24:27], v[16:19], v[120:123]
    ds_read_b64_tr_b16 v[68:69], v7 offset:8192
    s_cselect_b32 s46, 98304, s46
    v_mfma_f32_16x16x32_bf16 v[124:127], v[28:31], v[16:19], v[124:127]
    ds_read_b64_tr_b16 v[70:71], v7 offset:8704
    v_mfma_f32_16x16x32_bf16 v[128:131], v[32:35], v[16:19], v[128:131]
    v_add_u32 v6, s46, v4
    v_mfma_f32_16x16x32_bf16 v[132:135], v[36:39], v[16:19], v[132:135]
    v_add_u32 v7, s46, v5
    v_mfma_f32_16x16x32_bf16 v[136:139], v[16:19], v[40:43], v[136:139]
    v_mfma_f32_16x16x32_bf16 v[140:143], v[16:19], v[44:47], v[140:143]
    ds_read_b128 v[16:19], v1 offset:4096
    s_waitcnt lgkmcnt(14)
    v_mfma_f32_16x16x32_bf16 v[164:167], v[20:23], v[44:47], v[164:167]
    v_mfma_f32_16x16x32_bf16 v[160:163], v[20:23], v[40:43], v[160:163]
    v_mfma_f32_16x16x32_bf16 v[156:159], v[36:39], v[20:23], v[156:159]
    v_mfma_f32_16x16x32_bf16 v[152:155], v[32:35], v[20:23], v[152:155]
    v_mfma_f32_16x16x32_bf16 v[148:151], v[28:31], v[20:23], v[148:151]
    v_mfma_f32_16x16x32_bf16 v[144:147], v[24:27], v[20:23], v[144:147]
    ds_read_b128 v[20:23], v1 offset:6144
    s_waitcnt lgkmcnt(1)
    v_mfma_f32_16x16x32_bf16 v[72:75], v[48:51], v[8:11], v[72:75]
    v_mfma_f32_16x16x32_bf16 v[76:79], v[52:55], v[8:11], v[76:79]
    v_mfma_f32_16x16x32_bf16 v[80:83], v[56:59], v[8:11], v[80:83]
    v_mfma_f32_16x16x32_bf16 v[84:87], v[60:63], v[8:11], v[84:87]
    s_waitcnt lgkmcnt(0)
    s_barrier
    v_mfma_f32_16x16x32_bf16 v[88:91], v[8:11], v[64:67], v[88:91]
    ds_read_b64_tr_b16 v[24:25], v6 offset:0
    v_mfma_f32_16x16x32_bf16 v[92:95], v[8:11], v[68:71], v[92:95]
    ds_read_b128 v[8:11], v0 offset:0
    v_mfma_f32_16x16x32_bf16 v[116:119], v[12:15], v[68:71], v[116:119]
    ds_read_b64_tr_b16 v[26:27], v6 offset:512
    v_add_u32 v1, s44, v3
    v_mfma_f32_16x16x32_bf16 v[112:115], v[12:15], v[64:67], v[112:115]
    ds_read_b64_tr_b16 v[28:29], v7 offset:0
    s_sub_u32 s40, s40, 1
    v_mfma_f32_16x16x32_bf16 v[108:111], v[60:63], v[12:15], v[108:111]
    ds_read_b64_tr_b16 v[30:31], v7 offset:512
    s_add_u32 s46, s46, 12288
    v_mfma_f32_16x16x32_bf16 v[104:107], v[56:59], v[12:15], v[104:107]
    ds_read_b64_tr_b16 v[32:33], v6 offset:4096
    s_cmp_eq_u32 s46, 159744
    v_mfma_f32_16x16x32_bf16 v[100:103], v[52:55], v[12:15], v[100:103]
    ds_read_b64_tr_b16 v[34:35], v6 offset:4608
    s_cselect_b32 s46, 98304, s46
    v_mfma_f32_16x16x32_bf16 v[96:99], v[48:51], v[12:15], v[96:99]
    ds_read_b128 v[12:15], v0 offset:2048
    v_mfma_f32_16x16x32_bf16 v[120:123], v[48:51], v[16:19], v[120:123]
    ds_read_b64_tr_b16 v[36:37], v7 offset:4096
    v_mfma_f32_16x16x32_bf16 v[124:127], v[52:55], v[16:19], v[124:127]
    ds_read_b64_tr_b16 v[38:39], v7 offset:4608
    v_mfma_f32_16x16x32_bf16 v[128:131], v[56:59], v[16:19], v[128:131]
    ds_read_b64_tr_b16 v[40:41], v6 offset:8192
    v_mfma_f32_16x16x32_bf16 v[132:135], v[60:63], v[16:19], v[132:135]
    ds_read_b64_tr_b16 v[42:43], v6 offset:8704
    v_mfma_f32_16x16x32_bf16 v[136:139], v[16:19], v[64:67], v[136:139]
    ds_read_b64_tr_b16 v[44:45], v7 offset:8192
    v_mfma_f32_16x16x32_bf16 v[140:143], v[16:19], v[68:71], v[140:143]
    ds_read_b128 v[16:19], v0 offset:4096
    v_mfma_f32_16x16x32_bf16 v[164:167], v[20:23], v[68:71], v[164:167]
    ds_read_b64_tr_b16 v[46:47], v7 offset:8704
    v_mfma_f32_16x16x32_bf16 v[160:163], v[20:23], v[64:67], v[160:163]
    v_add_u32 v6, s46, v4
    v_mfma_f32_16x16x32_bf16 v[156:159], v[60:63], v[20:23], v[156:159]
    v_add_u32 v7, s46, v5
    v_mfma_f32_16x16x32_bf16 v[152:155], v[56:59], v[20:23], v[152:155]
    v_mfma_f32_16x16x32_bf16 v[148:151], v[52:55], v[20:23], v[148:151]
    s_cmp_lg_u32 s40, 0
    v_mfma_f32_16x16x32_bf16 v[144:147], v[48:51], v[20:23], v[144:147]
    ds_read_b128 v[20:23], v0 offset:6144
    s_cbranch_scc1 P1_loop
    v_mbcnt_lo_u32_b32 v1, -1, 0
    v_mbcnt_hi_u32_b32 v1, -1, v1
    v_lshlrev_b32 v1, 4, v1
    s_waitcnt lgkmcnt(0)
    s_cmp_lg_u32 s16, 0
    s_cbranch_scc1 P1_bepi
    s_and_b32 s36, s19, 1
    s_mul_i32 s36, s36, 24576
    s_lshr_b32 s37, s19, 1
    s_lshl_b32 s37, s37, 13
    s_add_u32 s36, s36, s37
    s_add_u32 s36, s36, 106496
    v_add_u32 v6, s36, v1
    s_lshl_b32 s37, s19, 11
    s_and_b32 s37, s37, 0x3000
    s_add_u32 s37, s37, 98304
    v_add_u32 v7, s37, v1
    s_bitcmp1_b32 0xab, s19
    s_cbranch_scc0 P1_np
    s_setprio 2
P1_np:
    s_cmp_lt_u32 s19, 2
    s_cbranch_scc1 P1_kv
P1_q:
    v_pk_mul_f32 v[72:73], v[72:73], s[42:43]
    v_pk_mul_f32 v[74:75], v[74:75], s[42:43]
    v_cvt_pk_bf16_f32 v8, v72, v73
    v_cvt_pk_bf16_f32 v9, v74, v75
    v_pk_mul_f32 v[76:77], v[76:77], s[42:43]
    v_pk_mul_f32 v[78:79], v[78:79], s[42:43]
    v_cvt_pk_bf16_f32 v10, v76, v77
    v_cvt_pk_bf16_f32 v11, v78, v79
    v_pk_mul_f32 v[96:97], v[96:97], s[42:43]
    v_pk_mul_f32 v[98:99], v[98:99], s[42:43]
    v_cvt_pk_bf16_f32 v12, v96, v97
    v_cvt_pk_bf16_f32 v13, v98, v99
    v_pk_mul_f32 v[100:101], v[100:101], s[42:43]
    v_pk_mul_f32 v[102:103], v[102:103], s[42:43]
    v_cvt_pk_bf16_f32 v14, v100, v101
    v_cvt_pk_bf16_f32 v15, v102, v103
    v_pk_mul_f32 v[120:121], v[120:121], s[42:43]
    v_pk_mul_f32 v[122:123], v[122:123], s[42:43]
    v_cvt_pk_bf16_f32 v16, v120, v121
    v_cvt_pk_bf16_f32 v17, v122, v123
    v_pk_mul_f32 v[124:125], v[124:125], s[42:43]
    v_pk_mul_f32 v[126:127], v[126:127], s[42:43]
    v_cvt_pk_bf16_f32 v18, v124, v125
    v_cvt_pk_bf16_f32 v19, v126, v127
    v_pk_mul_f32 v[144:145], v[144:145], s[42:43]
    v_pk_mul_f32 v[146:147], v[146:147], s[42:43]
    v_cvt_pk_bf16_f32 v20, v144, v145
    v_cvt_pk_bf16_f32 v21, v146, v147
    v_pk_mul_f32 v[148:149], v[148:149], s[42:43]
    v_pk_mul_f32 v[150:151], v[150:151], s[42:43]
    v_cvt_pk_bf16_f32 v22, v148, v149
    v_cvt_pk_bf16_f32 v23, v150, v151
    s_bitcmp0_b32 s19, 0
    s_cbranch_scc1 P1_ql
    buffer_store_dwordx4 v[8:11], v1, s[12:15], s64 offen offset:0 sc1
    buffer_store_dwordx4 v[12:15], v1, s[12:15], s64 offen offset:1024 sc1
    buffer_store_dwordx4 v[16:19], v1, s[12:15], s65 offen offset:0 sc1
    buffer_store_dwordx4 v[20:23], v1, s[12:15], s65 offen offset:1024 sc1
    s_branch P1_qd
P1_ql:
    ds_write_b128 v7, v[8:11] offset:0
    ds_write_b128 v7, v[12:15] offset:1024
    ds_write_b128 v7, v[16:19] offset:2048
    ds_write_b128 v7, v[20:23] offset:3072
P1_qd:
    s_cmp_lt_u32 s19, 2
    s_cbranch_scc1 P1_parked
P1_kv:
    v_cvt_pk_bf16_f32 v40, v88, v89
    v_cvt_pk_bf16_f32 v41, v90, v91
    v_cvt_pk_bf16_f32 v42, v112, v113
    v_cvt_pk_bf16_f32 v43, v114, v115
    v_cvt_pk_bf16_f32 v44, v92, v93
    v_cvt_pk_bf16_f32 v45, v94, v95
    v_cvt_pk_bf16_f32 v46, v116, v117
    v_cvt_pk_bf16_f32 v47, v118, v119
    v_cvt_pk_bf16_f32 v48, v136, v137
    v_cvt_pk_bf16_f32 v49, v138, v139
    v_cvt_pk_bf16_f32 v50, v160, v161
    v_cvt_pk_bf16_f32 v51, v162, v163
    v_cvt_pk_bf16_f32 v52, v140, v141
    v_cvt_pk_bf16_f32 v53, v142, v143
    v_cvt_pk_bf16_f32 v54, v164, v165
    v_cvt_pk_bf16_f32 v55, v166, v167
    v_cvt_pk_bf16_f32 v24, v80, v81
    v_cvt_pk_bf16_f32 v25, v82, v83
    v_cvt_pk_bf16_f32 v26, v84, v85
    v_cvt_pk_bf16_f32 v27, v86, v87
    v_cvt_pk_bf16_f32 v28, v104, v105
    v_cvt_pk_bf16_f32 v29, v106, v107
    v_cvt_pk_bf16_f32 v30, v108, v109
    v_cvt_pk_bf16_f32 v31, v110, v111
    v_cvt_pk_bf16_f32 v32, v128, v129
    v_cvt_pk_bf16_f32 v33, v130, v131
    v_cvt_pk_bf16_f32 v34, v132, v133
    v_cvt_pk_bf16_f32 v35, v134, v135
    v_cvt_pk_bf16_f32 v36, v152, v153
    v_cvt_pk_bf16_f32 v37, v154, v155
    v_cvt_pk_bf16_f32 v38, v156, v157
    v_cvt_pk_bf16_f32 v39, v158, v159
    v_permlane16_swap_b32 v40, v42
    v_permlane16_swap_b32 v41, v43
    v_permlane16_swap_b32 v44, v46
    v_permlane16_swap_b32 v45, v47
    v_permlane16_swap_b32 v48, v50
    v_permlane16_swap_b32 v49, v51
    v_permlane16_swap_b32 v52, v54
    v_permlane16_swap_b32 v53, v55
    s_cmp_gt_u32 s19, 1
    s_cbranch_scc1 P1_park
    buffer_store_dwordx4 v[24:27], v1, s[12:15], s66 offen offset:0 sc1
    buffer_store_dwordx4 v[28:31], v1, s[12:15], s66 offen offset:1024 sc1
    buffer_store_dwordx4 v[32:35], v1, s[12:15], s67 offen offset:0 sc1
    buffer_store_dwordx4 v[36:39], v1, s[12:15], s67 offen offset:1024 sc1
    buffer_store_dwordx4 v[40:43], v1, s[12:15], s66 offen offset:2048 sc1
    buffer_store_dwordx4 v[44:47], v1, s[12:15], s66 offen offset:3072 sc1
    buffer_store_dwordx4 v[48:51], v1, s[12:15], s67 offen offset:2048 sc1
    buffer_store_dwordx4 v[52:55], v1, s[12:15], s67 offen offset:3072 sc1
    s_branch P1_q
P1_park:
    ds_write_b128 v6, v[24:27] offset:0
    ds_write_b128 v6, v[28:31] offset:1024
    ds_write_b128 v6, v[32:35] offset:4096
    ds_write_b128 v6, v[36:39] offset:5120
    ds_write_b128 v6, v[40:43] offset:2048
    ds_write_b128 v6, v[44:47] offset:3072
    ds_write_b128 v6, v[48:51] offset:6144
    ds_write_b128 v6, v[52:55] offset:7168
P1_parked:
    s_setprio 0
    s_waitcnt vmcnt(0) lgkmcnt(0)
    s_barrier
P2_compute:
    s_lshl_b32 s36, s18, 1
    s_add_u32 s16, s16, s36
    s_lshl_b32 s36, s16, 18
    s_add_u32 s36, s36, 4194304
    s_add_u32 s4, s92, s36
    s_addc_u32 s5, s93, 0
    s_mov_b32 s6, 0x40000
    s_mov_b32 s24, 0
    v_lshrrev_b32 v6, 4, v1
    s_lshr_b32 s18, s19, 2
    s_and_b32 s20, s19, 3
    s_lshl_b32 s20, s20, 1
    s_add_u32 s20, s20, s18
    s_lshl_b32 s26, s17, 3
    s_add_u32 s26, s26, s20
    s_lshl_b32 s39, s18, 13
    v_and_b32 v31, 15, v6
    v_lshlrev_b32 v31, 4, v31
    v_and_b32 v5, 16, v6
    v_lshl_add_u32 v31, v5, 6, v31
    v_and_b32 v5, 32, v6
    v_lshl_add_u32 v31, v5, 4, v31
    s_lshl_b32 s31, s26, 5
    s_add_u32 s31, s31, s16
    s_lshl_b32 s31, s31, 11
    s_add_u32 s31, s31, 25165824
    v_mov_b32 v4, 0xdddd
    v_and_b32 v5, 4, v6
    v_cmp_eq_u32 vcc, 0, v5
    v_mov_b32 v7, 0x3f803f80
    v_add_u32 v30, s39, v31
    v_cndmask_b32 v8, 0, v7, vcc
    v_cndmask_b32 v9, 0, v7, vcc
    v_sub_u32 v10, v7, v8
    v_mov_b32 v11, v10
    s_lshl_b32 s27, s20, 11
    s_add_u32 s27, s27, 98304
    v_add_u32 v5, s27, v31
    v_xor_b32 v6, 2048, v5
P2_restart:
    v_mov_b64 v[96:97], 0
    v_mov_b64 v[98:99], 0
    v_mov_b64 v[100:101], 0
    v_mov_b64 v[102:103], 0
    v_mov_b64 v[104:105], 0
    v_mov_b64 v[106:107], 0
    v_mov_b64 v[108:109], 0
    v_mov_b64 v[110:111], 0
    v_mov_b64 v[80:81], 0
    v_mov_b64 v[82:83], 0
    v_mov_b64 v[112:113], 0
    v_mov_b64 v[114:115], 0
    v_mov_b64 v[116:117], 0
    v_mov_b64 v[118:119], 0
    v_mov_b64 v[120:121], 0
    v_mov_b64 v[122:123], 0
    v_mov_b64 v[124:125], 0
    v_mov_b64 v[126:127], 0
    v_mov_b64 v[84:85], 0
    v_mov_b64 v[86:87], 0
    v_mov_b32 v2, v30
    s_mov_b32 s25, 16384
    v_add_u32 v3, 16384, v30
    s_mov_b32 s23, 16
    s_barrier
    s_cmp_lg_u32 s24, 0
    s_cbranch_scc1 P2_main
    ds_read_b128 v[20:23], v31 offset:0
    ds_read_b128 v[64:67], v5
    ds_read_b128 v[72:75], v6
    ds_read_b128 v[24:27], v31 offset:256
    ds_read_b128 v[68:71], v5 offset:256
    ds_read_b128 v[76:79], v6 offset:256
    s_waitcnt lgkmcnt(3)
    v_mfma_f32_32x32x16_bf16 v[32:47], v[20:23], v[64:67], 0
    v_mfma_f32_32x32x16_bf16 v[48:63], v[20:23], v[72:75], 0
    s_waitcnt lgkmcnt(0)
    v_mfma_f32_32x32x16_bf16 v[32:47], v[24:27], v[68:71], v[32:47]
    v_mfma_f32_32x32x16_bf16 v[48:63], v[24:27], v[76:79], v[48:63]
    s_nop 7
    s_nop 2
    v_max3_f32 v28, v32, v33, v34
    v_max3_f32 v28, v35, v36, v28
    v_max3_f32 v28, v37, v38, v28
    v_max3_f32 v28, v39, v40, v28
    v_max3_f32 v28, v41, v42, v28
    v_max3_f32 v28, v43, v44, v28
    v_max3_f32 v28, v45, v46, v28
    v_max_f32 v28, v47, v28
    v_mov_b32 v6, v28
    s_nop 1
    v_permlane32_swap_b32 v28, v6
    s_nop 1
    v_max_f32 v28, v28, v6
    v_max3_f32 v29, v48, v49, v50
    v_max3_f32 v29, v51, v52, v29
    v_max3_f32 v29, v53, v54, v29
    v_max3_f32 v29, v55, v56, v29
    v_max3_f32 v29, v57, v58, v29
    v_max3_f32 v29, v59, v60, v29
    v_max3_f32 v29, v61, v62, v29
    v_max_f32 v29, v63, v29
    v_mov_b32 v6, v29
    s_nop 1
    v_permlane32_swap_b32 v29, v6
    s_nop 1
    v_max_f32 v29, v29, v6
P2_main:
    ds_read_b128 v[12:15], v2 offset:0
    ds_read_b128 v[16:19], v2 offset:256
    ds_read_b128 v[20:23], v2 offset:2048
    v_sub_f32 v128, 0, v28
    v_sub_f32 v129, 0, v28
    v_mov_b64 v[130:131], v[128:129]
    v_mov_b64 v[132:133], v[128:129]
    v_mov_b64 v[134:135], v[128:129]
    v_mov_b64 v[136:137], v[128:129]
    v_mov_b64 v[138:139], v[128:129]
    v_mov_b64 v[140:141], v[128:129]
    v_mov_b64 v[142:143], v[128:129]
    v_mov_b64 v[24:25], 0
    v_mov_b64 v[26:27], 0
    s_waitcnt lgkmcnt(1)
    v_mfma_f32_32x32x16_bf16 v[32:47], v[12:15], v[64:67], v[128:143]
    v_mfma_f32_32x32x16_bf16 v[32:47], v[16:19], v[68:71], v[32:47]
    v_sub_f32 v144, 0, v29
    v_sub_f32 v145, 0, v29
    v_mov_b64 v[146:147], v[144:145]
    v_mov_b64 v[148:149], v[144:145]
    v_mov_b64 v[150:151], v[144:145]
    v_mov_b64 v[152:153], v[144:145]
    v_mov_b64 v[154:155], v[144:145]
    v_mov_b64 v[156:157], v[144:145]
    v_mov_b64 v[158:159], v[144:145]
    v_mov_b64 v[56:57], 0
    v_mov_b64 v[58:59], 0
    v_mov_b64 v[60:61], 0
    v_mov_b64 v[62:63], 0
    v_exp_f32 v32, v32
    s_nop 0
.p2align 6
P2_loop:
    v_smfmac_f32_16x16x64_bf16 v[84:87], v[8:11], v[56:63], v4
    v_exp_f32 v33, v33
    v_exp_f32 v34, v34
    v_smfmac_f32_32x32x32_bf16 v[112:127], v[24:27], v[56:63], v4
    ds_read_b128 v[24:27], v2 offset:2304
    v_exp_f32 v35, v35
    v_exp_f32 v36, v36
    v_exp_f32 v37, v37
    v_mfma_f32_32x32x16_bf16 v[48:63], v[12:15], v[72:75], v[144:159]
    ds_read_b128 v[12:15], v2 offset:4096
    v_exp_f32 v38, v38
    v_exp_f32 v39, v39
    v_exp_f32 v40, v40
    v_mfma_f32_32x32x16_bf16 v[48:63], v[16:19], v[76:79], v[48:63]
    ds_read_b128 v[16:19], v2 offset:4352
    v_exp_f32 v41, v41
    v_exp_f32 v42, v42
    v_exp_f32 v43, v43
    v_smfmac_f32_16x16x64_bf16 v[80:83], v[8:11], v[32:39], v4
    v_exp_f32 v44, v44
    v_exp_f32 v45, v45
    s_waitcnt lgkmcnt(3)
    v_smfmac_f32_32x32x32_bf16 v[96:111], v[20:23], v[32:39], v4
    s_nop 0
    v_exp_f32 v46, v46
    v_exp_f32 v47, v47
    v_exp_f32 v48, v48
    s_waitcnt vmcnt(0)
    v_smfmac_f32_16x16x64_bf16 v[80:83], v[8:11], v[40:47], v4
    v_exp_f32 v49, v49
    v_exp_f32 v50, v50
    s_waitcnt lgkmcnt(2)
    v_smfmac_f32_32x32x32_bf16 v[96:111], v[24:27], v[40:47], v4
    v_exp_f32 v51, v51
    v_exp_f32 v52, v52
    v_exp_f32 v53, v53
    s_waitcnt lgkmcnt(0)
    v_mfma_f32_32x32x16_bf16 v[32:47], v[12:15], v[64:67], v[128:143]
    v_exp_f32 v54, v54
    v_exp_f32 v55, v55
    v_exp_f32 v56, v56
    v_mfma_f32_32x32x16_bf16 v[32:47], v[16:19], v[68:71], v[32:47]
    s_barrier
    v_exp_f32 v57, v57
    v_exp_f32 v58, v58
    v_exp_f32 v59, v59
    v_smfmac_f32_16x16x64_bf16 v[84:87], v[8:11], v[48:55], v4
    v_exp_f32 v60, v60
    v_exp_f32 v61, v61
    v_smfmac_f32_32x32x32_bf16 v[112:127], v[20:23], v[48:55], v4
    ds_read_b128 v[20:23], v2 offset:6144
    s_nop 0
    v_exp_f32 v62, v62
    v_exp_f32 v63, v63
    v_exp_f32 v32, v32
    s_nop 0
    v_smfmac_f32_16x16x64_bf16 v[84:87], v[8:11], v[56:63], v4
    v_exp_f32 v33, v33
    v_exp_f32 v34, v34
    v_smfmac_f32_32x32x32_bf16 v[112:127], v[24:27], v[56:63], v4
    ds_read_b128 v[24:27], v2 offset:6400
    v_exp_f32 v35, v35
    v_exp_f32 v36, v36
    v_exp_f32 v37, v37
    v_mfma_f32_32x32x16_bf16 v[48:63], v[12:15], v[72:75], v[144:159]
    ds_read_b128 v[12:15], v3 offset:0
    v_exp_f32 v38, v38
    v_exp_f32 v39, v39
    v_exp_f32 v40, v40
    v_mfma_f32_32x32x16_bf16 v[48:63], v[16:19], v[76:79], v[48:63]
    ds_read_b128 v[16:19], v3 offset:256
    v_exp_f32 v41, v41
    v_exp_f32 v42, v42
    v_exp_f32 v43, v43
    v_smfmac_f32_16x16x64_bf16 v[80:83], v[8:11], v[32:39], v4
    v_exp_f32 v44, v44
    v_exp_f32 v45, v45
    s_waitcnt lgkmcnt(3)
    v_smfmac_f32_32x32x32_bf16 v[96:111], v[20:23], v[32:39], v4
    s_nop 0
    v_exp_f32 v46, v46
    v_exp_f32 v47, v47
    v_exp_f32 v48, v48
    s_add_u32 s25, s25, 16384
    v_smfmac_f32_16x16x64_bf16 v[80:83], v[8:11], v[40:47], v4
    v_exp_f32 v49, v49
    v_exp_f32 v50, v50
    s_waitcnt lgkmcnt(2)
    v_smfmac_f32_32x32x32_bf16 v[96:111], v[24:27], v[40:47], v4
    s_cmp_eq_u32 s25, 98304
    v_exp_f32 v51, v51
    v_exp_f32 v52, v52
    v_exp_f32 v53, v53
    s_waitcnt lgkmcnt(0)
    v_mfma_f32_32x32x16_bf16 v[32:47], v[12:15], v[64:67], v[128:143]
    s_cselect_b32 s25, 0, s25
    v_exp_f32 v54, v54
    v_exp_f32 v55, v55
    v_exp_f32 v56, v56
    v_mfma_f32_32x32x16_bf16 v[32:47], v[16:19], v[68:71], v[32:47]
    s_sub_u32 s23, s23, 1
    v_exp_f32 v57, v57
    v_exp_f32 v58, v58
    v_exp_f32 v59, v59
    v_smfmac_f32_16x16x64_bf16 v[84:87], v[8:11], v[48:55], v4
    s_cmp_lg_u32 s23, 0
    v_exp_f32 v60, v60
    v_exp_f32 v61, v61
    v_smfmac_f32_32x32x32_bf16 v[112:127], v[20:23], v[48:55], v4
    ds_read_b128 v[20:23], v3 offset:2048
    v_mov_b32 v2, v3
    v_add_u32 v3, s25, v30
    v_exp_f32 v62, v62
    v_exp_f32 v63, v63
    v_exp_f32 v32, v32
    s_cbranch_scc1 P2_loop
    s_waitcnt lgkmcnt(0)
    v_smfmac_f32_32x32x32_bf16 v[112:127], v[24:27], v[56:63], v4
    v_smfmac_f32_16x16x64_bf16 v[84:87], v[8:11], v[56:63], v4
    s_mov_b32 s44, 1535115264
    s_mul_i32 s36, s19, 5120
    v_add_u32 v7, s36, v1
    v_mul_f32 v5, s44, v80
    v_maximum3_f32 v5, |v96|, |v97|, v5
    v_maximum3_f32 v5, |v98|, |v99|, v5
    v_maximum3_f32 v5, |v100|, |v101|, v5
    v_maximum3_f32 v5, |v102|, |v103|, v5
    v_maximum3_f32 v5, |v104|, |v105|, v5
    v_maximum3_f32 v5, |v106|, |v107|, v5
    v_maximum3_f32 v5, |v108|, |v109|, v5
    v_maximum3_f32 v5, |v110|, |v111|, v5
    s_mov_b32 s45, 2071986176
    ds_write_b128 v7, v[112:115] offset:0
    ds_write_b128 v7, v[116:119] offset:1024
    ds_write_b128 v7, v[120:123] offset:2048
    ds_write_b128 v7, v[124:127] offset:3072
    ds_write_b32 v7, v84 offset:4096
    v_mul_f32 v6, s44, v84
    v_maximum3_f32 v6, |v112|, |v113|, v6
    v_maximum3_f32 v6, |v114|, |v115|, v6
    v_maximum3_f32 v6, |v116|, |v117|, v6
    v_maximum3_f32 v6, |v118|, |v119|, v6
    v_maximum3_f32 v6, |v120|, |v121|, v6
    v_maximum3_f32 v6, |v122|, |v123|, v6
    v_maximum3_f32 v6, |v124|, |v125|, v6
    v_maximum3_f32 v6, |v126|, |v127|, v6
    v_maximum3_f32 v5, v5, v6, v6
    s_lshl_b32 s36, s19, 2
    s_add_u32 s36, s36, 40960
    v_cmp_ngt_f32 vcc, s45, v5
    v_mov_b32 v7, s36
    s_xor_b32 s36, s19, 4
    s_mul_i32 s36, s36, 5120
    v_add_u32 v3, s36, v1
    s_cmp_lg_u64 vcc, 0
    s_cselect_b32 s44, 1, 0
    v_mov_b32 v6, s44
    ds_write_b32 v7, v6
    s_waitcnt lgkmcnt(0)
    s_barrier
    ds_read_b32 v5, v3 offset:4096
    ds_read_b128 v[32:35], v3 offset:0
    ds_read_b128 v[36:39], v3 offset:1024
    ds_read_b128 v[40:43], v3 offset:2048
    ds_read_b128 v[44:47], v3 offset:3072
    v_mov_b32 v7, 40960
    ds_read_b128 v[48:51], v7
    ds_read_b128 v[52:55], v7 offset:16
    s_waitcnt lgkmcnt(2)
    v_add_f32 v6, v5, v80
    v_rcp_f32 v6, v6
    v_pk_add_f32 v[96:97], v[32:33], v[96:97]
    v_pk_add_f32 v[98:99], v[34:35], v[98:99]
    v_pk_add_f32 v[100:101], v[36:37], v[100:101]
    v_pk_add_f32 v[102:103], v[38:39], v[102:103]
    v_pk_add_f32 v[104:105], v[40:41], v[104:105]
    v_pk_add_f32 v[106:107], v[42:43], v[106:107]
    v_pk_add_f32 v[108:109], v[44:45], v[108:109]
    v_pk_add_f32 v[110:111], v[46:47], v[110:111]
    v_pk_mul_f32 v[96:97], v[96:97], v[6:7] op_sel_hi:[1,0]
    v_pk_mul_f32 v[98:99], v[98:99], v[6:7] op_sel_hi:[1,0]
    v_pk_mul_f32 v[100:101], v[100:101], v[6:7] op_sel_hi:[1,0]
    v_pk_mul_f32 v[102:103], v[102:103], v[6:7] op_sel_hi:[1,0]
    v_pk_mul_f32 v[104:105], v[104:105], v[6:7] op_sel_hi:[1,0]
    v_pk_mul_f32 v[106:107], v[106:107], v[6:7] op_sel_hi:[1,0]
    v_pk_mul_f32 v[108:109], v[108:109], v[6:7] op_sel_hi:[1,0]
    v_pk_mul_f32 v[110:111], v[110:111], v[6:7] op_sel_hi:[1,0]
    v_cvt_pk_bf16_f32 v32, v96, v97
    v_cvt_pk_bf16_f32 v33, v98, v99
    v_cvt_pk_bf16_f32 v34, v100, v101
    v_cvt_pk_bf16_f32 v35, v102, v103
    v_cvt_pk_bf16_f32 v36, v104, v105
    v_cvt_pk_bf16_f32 v37, v106, v107
    v_cvt_pk_bf16_f32 v38, v108, v109
    v_cvt_pk_bf16_f32 v39, v110, v111
    buffer_store_dwordx4 v[32:35], v1, s[12:15], s31 offen offset:0 sc1
    buffer_store_dwordx4 v[36:39], v1, s[12:15], s31 offen offset:1024 sc1
    s_cmp_lg_u32 s24, 0
    s_cbranch_scc1 P2_fin
    s_waitcnt lgkmcnt(0)
    v_or3_b32 v48, v48, v52, v53
    v_or3_b32 v48, v48, v54, v55
    v_or3_b32 v48, v48, v49, v50
    v_or_b32 v48, v48, v51
    s_nop 0
    v_readfirstlane_b32 s44, v48
    s_nop 3
    s_cmp_eq_u32 s44, 0
    s_cbranch_scc0 P2_fallback
P2_fin:
    s_waitcnt vmcnt(0)
    s_barrier
    s_cmp_gt_u32 s19, 3
    s_cbranch_scc1 L_done
    s_lshr_b32 s16, s34, 2
    s_and_b32 s17, s34, 1
    s_lshl_b32 s17, s17, 3
    s_and_b32 s36, s35, 7
    s_add_u32 s17, s17, s36
    s_lshr_b32 s18, s34, 1
    s_and_b32 s18, s18, 1
    s_lshl_b32 s18, s18, 2
    s_lshr_b32 s36, s35, 3
    s_add_u32 s18, s18, s36
    v_lshrrev_b32 v1, 4, v1
    s_lshr_b32 s36, s19, 1
    s_and_b32 s37, s19, 1
    v_lshrrev_b32 v18, 4, v1
    v_and_b32 v17, 15, v1
    v_lshlrev_b32 v2, 4, v17
    v_lshl_add_u32 v2, v18, 9, v2
    s_lshl_b32 s38, s36, 13
    v_add_u32 v2, s38, v2
    v_lshrrev_b32 v19, 2, v1
    v_and_b32 v19, 7, v19
    v_lshrrev_b32 v20, 5, v1
    v_lshl_add_u32 v20, v20, 4, v19
    v_lshlrev_b32 v20, 8, v20
    s_lshl_b32 s38, s37, 2
    v_xor_b32 v21, s38, v19
    v_lshl_add_u32 v20, v21, 5, v20
    v_and_b32 v21, 3, v1
    v_lshl_add_u32 v3, v21, 3, v20
    v_xor_b32 v4, 32, v3
    v_xor_b32 v5, 64, v3
    v_xor_b32 v6, 96, v3
    v_mov_b64 v[88:89], 0
    v_mov_b64 v[90:91], 0
    v_mov_b64 v[92:93], 0
    v_mov_b64 v[94:95], 0
    v_mov_b64 v[96:97], 0
    v_mov_b64 v[98:99], 0
    v_mov_b64 v[100:101], 0
    v_mov_b64 v[102:103], 0
    v_mov_b64 v[104:105], 0
    v_mov_b64 v[106:107], 0
    v_mov_b64 v[108:109], 0
    v_mov_b64 v[110:111], 0
    v_mov_b64 v[112:113], 0
    v_mov_b64 v[114:115], 0
    v_mov_b64 v[116:117], 0
    v_mov_b64 v[118:119], 0
    v_mov_b64 v[120:121], 0
    v_mov_b64 v[122:123], 0
    v_mov_b64 v[124:125], 0
    v_mov_b64 v[126:127], 0
    v_mov_b64 v[128:129], 0
    v_mov_b64 v[130:131], 0
    v_mov_b64 v[132:133], 0
    v_mov_b64 v[134:135], 0
    v_mov_b64 v[136:137], 0
    v_mov_b64 v[138:139], 0
    v_mov_b64 v[140:141], 0
    v_mov_b64 v[142:143], 0
    v_mov_b64 v[144:145], 0
    v_mov_b64 v[146:147], 0
    v_mov_b64 v[148:149], 0
    v_mov_b64 v[150:151], 0
    v_mov_b64 v[56:57], 0
    v_mov_b64 v[58:59], 0
    v_mov_b64 v[60:61], 0
    v_mov_b64 v[62:63], 0
    v_mov_b64 v[64:65], 0
    v_mov_b64 v[66:67], 0
    v_mov_b64 v[68:69], 0
    v_mov_b64 v[70:71], 0
    v_mov_b64 v[72:73], 0
    v_mov_b64 v[74:75], 0
    v_mov_b64 v[76:77], 0
    v_mov_b64 v[78:79], 0
    v_mov_b64 v[80:81], 0
    v_mov_b64 v[82:83], 0
    v_mov_b64 v[84:85], 0
    v_mov_b64 v[86:87], 0
    v_lshlrev_b32 v22, 12, v17
    v_and_b32 v21, 1, v18
    v_lshl_add_u32 v22, v21, 5, v22
    v_lshrrev_b32 v21, 1, v18
    v_lshl_add_u32 v22, v21, 4, v22
    v_and_b32 v22, 0x7fff, v22
    v_and_b32 v21, 8, v1
    v_lshl_add_u32 v22, v21, 3, v22
    v_add_u32 v23, 32768, v22
    s_lshl_b32 s38, s17, 7
    s_lshl_b32 s36, s36, 6
    s_add_u32 s36, s36, s38
    s_lshl_b32 s36, s36, 12
    s_lshl_b32 s38, s16, 11
    s_add_u32 s36, s36, s38
    s_lshl_b32 s38, s18, 8
    s_add_u32 s36, s36, s38
    s_lshl_b32 s37, s37, 7
    s_add_u32 s40, s36, s37
    s_add_u32 s41, s40, 65536
    s_add_u32 s42, s40, 131072
    s_add_u32 s43, s40, 196608
    s_mov_b32 s8, s88
    s_mov_b32 s9, s89
    s_mov_b32 s10, 8388608
    s_mov_b32 s23, 0
    s_mov_b32 s22, 98304
    s_mov_b32 s38, 16
    v_mov_b32 v8, v2
    v_add_u32 v9, s22, v3
    v_add_u32 v10, s22, v4
    v_add_u32 v11, s22, v5
    v_add_u32 v12, s22, v6
.p2align 6
P3_loop:
    s_waitcnt lgkmcnt(0)
    s_barrier
    v_mfma_f32_16x16x32_bf16 v[88:91], v[72:75], v[56:59], v[88:91]
    ds_read_b128 v[24:27], v8 offset:0
    ds_read_b64_tr_b16 v[40:41], v9 offset:0
    v_mfma_f32_16x16x32_bf16 v[92:95], v[76:79], v[56:59], v[92:95]
    ds_read_b64_tr_b16 v[42:43], v9 offset:2048
    ds_read_b64_tr_b16 v[44:45], v10 offset:0
    v_mfma_f32_16x16x32_bf16 v[96:99], v[80:83], v[56:59], v[96:99]
    ds_read_b64_tr_b16 v[46:47], v10 offset:2048
    ds_read_b64_tr_b16 v[48:49], v11 offset:0
    v_mfma_f32_16x16x32_bf16 v[100:103], v[84:87], v[56:59], v[100:103]
    ds_read_b64_tr_b16 v[50:51], v11 offset:2048
    ds_read_b64_tr_b16 v[52:53], v12 offset:0
    v_mfma_f32_16x16x32_bf16 v[116:119], v[84:87], v[60:63], v[116:119]
    ds_read_b64_tr_b16 v[54:55], v12 offset:2048
    v_mfma_f32_16x16x32_bf16 v[112:115], v[80:83], v[60:63], v[112:115]
    ds_read_b128 v[28:31], v8 offset:256
    v_mfma_f32_16x16x32_bf16 v[108:111], v[76:79], v[60:63], v[108:111]
    ds_read_b128 v[32:35], v8 offset:4096
    v_mfma_f32_16x16x32_bf16 v[104:107], v[72:75], v[60:63], v[104:107]
    ds_read_b128 v[36:39], v8 offset:4352
    v_mfma_f32_16x16x32_bf16 v[120:123], v[72:75], v[64:67], v[120:123]
    s_add_u32 s23, s23, 16384
    v_mfma_f32_16x16x32_bf16 v[124:127], v[76:79], v[64:67], v[124:127]
    s_cmp_eq_u32 s23, 65536
    v_mfma_f32_16x16x32_bf16 v[128:131], v[80:83], v[64:67], v[128:131]
    s_cselect_b32 s23, 0, s23
    v_mfma_f32_16x16x32_bf16 v[132:135], v[84:87], v[64:67], v[132:135]
    s_add_u32 s22, s22, 16384
    v_mfma_f32_16x16x32_bf16 v[148:151], v[84:87], v[68:71], v[148:151]
    s_cmp_eq_u32 s22, 163840
    v_mfma_f32_16x16x32_bf16 v[144:147], v[80:83], v[68:71], v[144:147]
    s_cselect_b32 s22, 65536, s22
    v_mfma_f32_16x16x32_bf16 v[140:143], v[76:79], v[68:71], v[140:143]
    s_sub_u32 s38, s38, 1
    v_mfma_f32_16x16x32_bf16 v[136:139], v[72:75], v[68:71], v[136:139]
    s_waitcnt lgkmcnt(0)
    v_mfma_f32_16x16x32_bf16 v[88:91], v[40:43], v[24:27], v[88:91]
    ds_read_b128 v[56:59], v8 offset:2048
    ds_read_b64_tr_b16 v[72:73], v9 offset:8192
    v_mfma_f32_16x16x32_bf16 v[92:95], v[44:47], v[24:27], v[92:95]
    ds_read_b64_tr_b16 v[74:75], v9 offset:10240
    ds_read_b64_tr_b16 v[76:77], v10 offset:8192
    v_mfma_f32_16x16x32_bf16 v[96:99], v[48:51], v[24:27], v[96:99]
    ds_read_b64_tr_b16 v[78:79], v10 offset:10240
    ds_read_b64_tr_b16 v[80:81], v11 offset:8192
    v_mfma_f32_16x16x32_bf16 v[100:103], v[52:55], v[24:27], v[100:103]
    ds_read_b64_tr_b16 v[82:83], v11 offset:10240
    v_mfma_f32_16x16x32_bf16 v[116:119], v[52:55], v[28:31], v[116:119]
    ds_read_b64_tr_b16 v[84:85], v12 offset:8192
    v_mfma_f32_16x16x32_bf16 v[112:115], v[48:51], v[28:31], v[112:115]
    ds_read_b64_tr_b16 v[86:87], v12 offset:10240
    v_mfma_f32_16x16x32_bf16 v[108:111], v[44:47], v[28:31], v[108:111]
    ds_read_b128 v[60:63], v8 offset:2304
    v_mfma_f32_16x16x32_bf16 v[104:107], v[40:43], v[28:31], v[104:107]
    ds_read_b128 v[64:67], v8 offset:6144
    v_mfma_f32_16x16x32_bf16 v[120:123], v[40:43], v[32:35], v[120:123]
    ds_read_b128 v[68:71], v8 offset:6400
    v_mfma_f32_16x16x32_bf16 v[124:127], v[44:47], v[32:35], v[124:127]
    v_add_u32 v8, s23, v2
    v_mfma_f32_16x16x32_bf16 v[128:131], v[48:51], v[32:35], v[128:131]
    v_add_u32 v9, s22, v3
    v_mfma_f32_16x16x32_bf16 v[132:135], v[52:55], v[32:35], v[132:135]
    v_add_u32 v10, s22, v4
    v_mfma_f32_16x16x32_bf16 v[148:151], v[52:55], v[36:39], v[148:151]
    v_add_u32 v11, s22, v5
    v_mfma_f32_16x16x32_bf16 v[144:147], v[48:51], v[36:39], v[144:147]
    v_add_u32 v12, s22, v6
    v_mfma_f32_16x16x32_bf16 v[140:143], v[44:47], v[36:39], v[140:143]
    s_cmp_lg_u32 s38, 0
    v_mfma_f32_16x16x32_bf16 v[136:139], v[40:43], v[36:39], v[136:139]
    s_cbranch_scc1 P3_loop
    s_waitcnt lgkmcnt(0)
    v_mfma_f32_16x16x32_bf16 v[88:91], v[72:75], v[56:59], v[88:91]
    v_mfma_f32_16x16x32_bf16 v[92:95], v[76:79], v[56:59], v[92:95]
    v_mfma_f32_16x16x32_bf16 v[96:99], v[80:83], v[56:59], v[96:99]
    v_mfma_f32_16x16x32_bf16 v[100:103], v[84:87], v[56:59], v[100:103]
    v_mfma_f32_16x16x32_bf16 v[116:119], v[84:87], v[60:63], v[116:119]
    v_mfma_f32_16x16x32_bf16 v[112:115], v[80:83], v[60:63], v[112:115]
    v_mfma_f32_16x16x32_bf16 v[108:111], v[76:79], v[60:63], v[108:111]
    v_mfma_f32_16x16x32_bf16 v[104:107], v[72:75], v[60:63], v[104:107]
    v_mfma_f32_16x16x32_bf16 v[120:123], v[72:75], v[64:67], v[120:123]
    v_mfma_f32_16x16x32_bf16 v[124:127], v[76:79], v[64:67], v[124:127]
    v_cvt_pk_bf16_f32 v24, v88, v89
    v_cvt_pk_bf16_f32 v25, v90, v91
    v_mfma_f32_16x16x32_bf16 v[128:131], v[80:83], v[64:67], v[128:131]
    v_cvt_pk_bf16_f32 v26, v92, v93
    v_cvt_pk_bf16_f32 v27, v94, v95
    v_mfma_f32_16x16x32_bf16 v[132:135], v[84:87], v[64:67], v[132:135]
    v_cvt_pk_bf16_f32 v28, v96, v97
    v_cvt_pk_bf16_f32 v29, v98, v99
    v_mfma_f32_16x16x32_bf16 v[148:151], v[84:87], v[68:71], v[148:151]
    v_cvt_pk_bf16_f32 v30, v100, v101
    v_cvt_pk_bf16_f32 v31, v102, v103
    v_mfma_f32_16x16x32_bf16 v[144:147], v[80:83], v[68:71], v[144:147]
    v_permlane16_swap_b32 v24, v26
    v_permlane16_swap_b32 v25, v27
    v_mfma_f32_16x16x32_bf16 v[140:143], v[76:79], v[68:71], v[140:143]
    v_permlane16_swap_b32 v28, v30
    v_permlane16_swap_b32 v29, v31
    v_mfma_f32_16x16x32_bf16 v[136:139], v[72:75], v[68:71], v[136:139]
    v_mov_b64 v[8:9], v[24:25]
    v_mov_b64 v[10:11], v[26:27]
    v_mov_b32_dpp v24, v28 row_ror:8 row_mask:0xf bank_mask:0xc
    v_mov_b32_dpp v25, v29 row_ror:8 row_mask:0xf bank_mask:0xc
    v_mov_b32_dpp v26, v30 row_ror:8 row_mask:0xf bank_mask:0xc
    v_mov_b32_dpp v27, v31 row_ror:8 row_mask:0xf bank_mask:0xc
    buffer_store_dwordx4 v[24:27], v22, s[8:11], s40 offen sc1
    v_mov_b32_dpp v28, v8 row_ror:8 row_mask:0xf bank_mask:0x3
    v_mov_b32_dpp v29, v9 row_ror:8 row_mask:0xf bank_mask:0x3
    v_mov_b32_dpp v30, v10 row_ror:8 row_mask:0xf bank_mask:0x3
    v_mov_b32_dpp v31, v11 row_ror:8 row_mask:0xf bank_mask:0x3
    buffer_store_dwordx4 v[28:31], v23, s[8:11], s40 offen sc1
    v_cvt_pk_bf16_f32 v32, v104, v105
    v_cvt_pk_bf16_f32 v33, v106, v107
    v_cvt_pk_bf16_f32 v34, v108, v109
    v_cvt_pk_bf16_f32 v35, v110, v111
    v_cvt_pk_bf16_f32 v36, v112, v113
    v_cvt_pk_bf16_f32 v37, v114, v115
    v_cvt_pk_bf16_f32 v38, v116, v117
    v_cvt_pk_bf16_f32 v39, v118, v119
    v_permlane16_swap_b32 v32, v34
    v_permlane16_swap_b32 v33, v35
    v_permlane16_swap_b32 v36, v38
    v_permlane16_swap_b32 v37, v39
    v_mov_b64 v[12:13], v[32:33]
    v_mov_b64 v[14:15], v[34:35]
    v_mov_b32_dpp v32, v36 row_ror:8 row_mask:0xf bank_mask:0xc
    v_mov_b32_dpp v33, v37 row_ror:8 row_mask:0xf bank_mask:0xc
    v_mov_b32_dpp v34, v38 row_ror:8 row_mask:0xf bank_mask:0xc
    v_mov_b32_dpp v35, v39 row_ror:8 row_mask:0xf bank_mask:0xc
    buffer_store_dwordx4 v[32:35], v22, s[8:11], s41 offen sc1
    v_mov_b32_dpp v36, v12 row_ror:8 row_mask:0xf bank_mask:0x3
    v_mov_b32_dpp v37, v13 row_ror:8 row_mask:0xf bank_mask:0x3
    v_mov_b32_dpp v38, v14 row_ror:8 row_mask:0xf bank_mask:0x3
    v_mov_b32_dpp v39, v15 row_ror:8 row_mask:0xf bank_mask:0x3
    buffer_store_dwordx4 v[36:39], v23, s[8:11], s41 offen sc1
    v_cvt_pk_bf16_f32 v40, v120, v121
    v_cvt_pk_bf16_f32 v41, v122, v123
    v_cvt_pk_bf16_f32 v42, v124, v125
    v_cvt_pk_bf16_f32 v43, v126, v127
    v_cvt_pk_bf16_f32 v44, v128, v129
    v_cvt_pk_bf16_f32 v45, v130, v131
    v_cvt_pk_bf16_f32 v46, v132, v133
    v_cvt_pk_bf16_f32 v47, v134, v135
    v_permlane16_swap_b32 v40, v42
    v_permlane16_swap_b32 v41, v43
    v_permlane16_swap_b32 v44, v46
    v_permlane16_swap_b32 v45, v47
    v_mov_b64 v[8:9], v[40:41]
    v_mov_b64 v[10:11], v[42:43]
    v_mov_b32_dpp v40, v44 row_ror:8 row_mask:0xf bank_mask:0xc
    v_mov_b32_dpp v41, v45 row_ror:8 row_mask:0xf bank_mask:0xc
    v_mov_b32_dpp v42, v46 row_ror:8 row_mask:0xf bank_mask:0xc
    v_mov_b32_dpp v43, v47 row_ror:8 row_mask:0xf bank_mask:0xc
    buffer_store_dwordx4 v[40:43], v22, s[8:11], s42 offen sc1
    v_mov_b32_dpp v44, v8 row_ror:8 row_mask:0xf bank_mask:0x3
    v_mov_b32_dpp v45, v9 row_ror:8 row_mask:0xf bank_mask:0x3
    v_mov_b32_dpp v46, v10 row_ror:8 row_mask:0xf bank_mask:0x3
    v_mov_b32_dpp v47, v11 row_ror:8 row_mask:0xf bank_mask:0x3
    buffer_store_dwordx4 v[44:47], v23, s[8:11], s42 offen sc1
    v_cvt_pk_bf16_f32 v48, v136, v137
    v_cvt_pk_bf16_f32 v49, v138, v139
    v_cvt_pk_bf16_f32 v50, v140, v141
    v_cvt_pk_bf16_f32 v51, v142, v143
    v_cvt_pk_bf16_f32 v52, v144, v145
    v_cvt_pk_bf16_f32 v53, v146, v147
    v_cvt_pk_bf16_f32 v54, v148, v149
    v_cvt_pk_bf16_f32 v55, v150, v151
    v_permlane16_swap_b32 v48, v50
    v_permlane16_swap_b32 v49, v51
    v_permlane16_swap_b32 v52, v54
    v_permlane16_swap_b32 v53, v55
    v_mov_b64 v[12:13], v[48:49]
    v_mov_b64 v[14:15], v[50:51]
    v_mov_b32_dpp v48, v52 row_ror:8 row_mask:0xf bank_mask:0xc
    v_mov_b32_dpp v49, v53 row_ror:8 row_mask:0xf bank_mask:0xc
    v_mov_b32_dpp v50, v54 row_ror:8 row_mask:0xf bank_mask:0xc
    v_mov_b32_dpp v51, v55 row_ror:8 row_mask:0xf bank_mask:0xc
    buffer_store_dwordx4 v[48:51], v22, s[8:11], s43 offen sc1
    v_mov_b32_dpp v52, v12 row_ror:8 row_mask:0xf bank_mask:0x3
    v_mov_b32_dpp v53, v13 row_ror:8 row_mask:0xf bank_mask:0x3
    v_mov_b32_dpp v54, v14 row_ror:8 row_mask:0xf bank_mask:0x3
    v_mov_b32_dpp v55, v15 row_ror:8 row_mask:0xf bank_mask:0x3
    buffer_store_dwordx4 v[52:55], v23, s[8:11], s43 offen sc1
    s_endpgm
P3_oload:
    s_lshr_b32 s16, s34, 2
    s_and_b32 s17, s34, 1
    s_lshl_b32 s17, s17, 3
    s_and_b32 s36, s35, 7
    s_add_u32 s17, s17, s36
    s_lshr_b32 s18, s34, 1
    s_and_b32 s18, s18, 1
    s_lshl_b32 s18, s18, 2
    s_lshr_b32 s36, s35, 3
    s_add_u32 s18, s18, s36
    s_lshl_b32 s36, s16, 22
    s_lshl_b32 s37, s17, 18
    s_add_u32 s36, s36, s37
    s_add_u32 s36, s36, 25165824
    s_add_u32 s4, s92, s36
    s_addc_u32 s5, s93, 0
    s_mov_b32 s6, 0x40000
    s_lshl_b32 s21, s34, 13
    s_barrier
    v_mov_b32 v2, 1
    s_mov_b64 exec, 65535
    buffer_store_dword v2, v40, s[12:15], 0 offen sc1
    s_mov_b64 exec, -1
    s_mov_b32 s47, 30000
    s_lshl_b32 s46, s2, 8
    s_add_u32 s46, s46, 33554560
    v_lshrrev_b32 v3, 2, v1
    v_and_b32 v3, 127, v3
P3_o_poll:
    buffer_load_dword v2, v3, s[12:15], s46 offen sc1
    s_sub_u32 s47, s47, 1
    s_waitcnt vmcnt(0)
    v_cmp_eq_u32 vcc, 0, v2
    s_cmp_eq_u32 s47, 0
    s_cbranch_scc1 P3_o_go
    s_cmp_eq_u64 vcc, 0
    s_cbranch_scc1 P3_o_go
    s_branch P3_o_poll
P3_o_go:
    s_mov_b32 s23, 0
    s_mov_b32 s38, 0
P3_o_go2:
    s_add_u32 m0, s23, 0
    s_add_u32 s20, s21, 0
    buffer_load_dwordx4 v1, s[4:7], s20 offen offset:0 sc1 lds
    buffer_load_dwordx4 v1, s[4:7], s20 offen offset:1024 sc1 lds
    buffer_load_dwordx4 v1, s[4:7], s20 offen offset:2048 sc1 lds
    buffer_load_dwordx4 v1, s[4:7], s20 offen offset:3072 sc1 lds
    s_add_u32 m0, s23, 4096
    s_add_u32 s20, s21, 65536
    buffer_load_dwordx4 v1, s[4:7], s20 offen offset:0 sc1 lds
    buffer_load_dwordx4 v1, s[4:7], s20 offen offset:1024 sc1 lds
    buffer_load_dwordx4 v1, s[4:7], s20 offen offset:2048 sc1 lds
    buffer_load_dwordx4 v1, s[4:7], s20 offen offset:3072 sc1 lds
    s_add_u32 m0, s23, 8192
    s_add_u32 s20, s21, 131072
    buffer_load_dwordx4 v1, s[4:7], s20 offen offset:0 sc1 lds
    buffer_load_dwordx4 v1, s[4:7], s20 offen offset:1024 sc1 lds
    buffer_load_dwordx4 v1, s[4:7], s20 offen offset:2048 sc1 lds
    buffer_load_dwordx4 v1, s[4:7], s20 offen offset:3072 sc1 lds
    s_add_u32 m0, s23, 12288
    s_add_u32 s20, s21, 196608
    buffer_load_dwordx4 v1, s[4:7], s20 offen offset:0 sc1 lds
    buffer_load_dwordx4 v1, s[4:7], s20 offen offset:1024 sc1 lds
    buffer_load_dwordx4 v1, s[4:7], s20 offen offset:2048 sc1 lds
    buffer_load_dwordx4 v1, s[4:7], s20 offen offset:3072 sc1 lds
    s_add_u32 s21, s21, 4096
    s_and_b32 s21, s21, 0xffff
    s_add_u32 s38, s38, 1
    s_add_u32 s23, s23, 16384
    s_cmp_eq_u32 s23, 65536
    s_cselect_b32 s23, 0, s23
    s_cmp_eq_u32 s38, 2
    s_cbranch_scc0 P3_o_l1
    s_waitcnt vmcnt(16)
    s_barrier
P3_o_l1:
    s_cmp_lt_u32 s38, 4
    s_cbranch_scc1 P3_o_go2
    s_waitcnt vmcnt(32)
    s_barrier
    s_cmp_lt_u32 s38, 16
    s_cbranch_scc1 P3_o_go2
    s_waitcnt vmcnt(16)
    s_barrier
    s_waitcnt vmcnt(0)
    s_barrier
    s_endpgm
P1_bepi:
    s_lshl_b32 s36, s19, 11
    s_add_u32 s36, s36, 147456
    v_add_u32 v6, s36, v1
    v_cvt_pk_bf16_f32 v40, v152, v153
    v_cvt_pk_bf16_f32 v41, v154, v155
    v_cvt_pk_bf16_f32 v52, v160, v161
    v_cvt_pk_bf16_f32 v53, v162, v163
    v_cvt_pk_bf16_f32 v42, v156, v157
    v_cvt_pk_bf16_f32 v43, v158, v159
    v_cvt_pk_bf16_f32 v62, v164, v165
    v_cvt_pk_bf16_f32 v63, v166, v167
    ds_write_b128 v6, v[40:43]
    ds_write_b64 v6, v[52:53] offset:1024
    ds_write_b64 v6, v[62:63] offset:1032
    s_lshl_b32 s36, s18, 3
    s_add_u32 s36, s36, s17
    s_lshl_b32 s36, s36, 1
    s_and_b32 s37, s19, 1
    s_add_u32 s36, s36, s37
    s_lshl_b32 s36, s36, 11
    s_add_u32 s36, s36, 12582912
    s_cmp_lt_u32 s19, 6
    s_cbranch_scc1 P1_b1
    buffer_store_dwordx4 v[40:43], v1, s[12:15], s36 offen sc1
    buffer_store_dwordx2 v[52:53], v1, s[12:15], s36 offen offset:1024 sc1
    buffer_store_dwordx2 v[62:63], v1, s[12:15], s36 offen offset:1032 sc1
P1_b1:
    v_cvt_pk_bf16_f32 v28, v80, v81
    v_cvt_pk_bf16_f32 v29, v82, v83
    v_cvt_pk_bf16_f32 v46, v88, v89
    v_cvt_pk_bf16_f32 v47, v90, v91
    v_cvt_pk_bf16_f32 v30, v84, v85
    v_cvt_pk_bf16_f32 v31, v86, v87
    v_cvt_pk_bf16_f32 v56, v92, v93
    v_cvt_pk_bf16_f32 v57, v94, v95
    v_cvt_pk_bf16_f32 v32, v104, v105
    v_cvt_pk_bf16_f32 v33, v106, v107
    v_cvt_pk_bf16_f32 v48, v112, v113
    v_cvt_pk_bf16_f32 v49, v114, v115
    v_cvt_pk_bf16_f32 v34, v108, v109
    v_cvt_pk_bf16_f32 v35, v110, v111
    v_cvt_pk_bf16_f32 v58, v116, v117
    v_cvt_pk_bf16_f32 v59, v118, v119
    v_cvt_pk_bf16_f32 v36, v128, v129
    v_cvt_pk_bf16_f32 v37, v130, v131
    v_cvt_pk_bf16_f32 v50, v136, v137
    v_cvt_pk_bf16_f32 v51, v138, v139
    v_cvt_pk_bf16_f32 v38, v132, v133
    v_cvt_pk_bf16_f32 v39, v134, v135
    v_cvt_pk_bf16_f32 v60, v140, v141
    v_cvt_pk_bf16_f32 v61, v142, v143
    s_waitcnt lgkmcnt(0)
    s_barrier
    v_subrev_u32 v6, 4096, v6
    ds_read_b128 v[24:27], v6
    ds_read_b64 v[44:45], v6 offset:1024
    ds_read_b64 v[54:55], v6 offset:1032
    v_pk_mul_f32 v[72:73], v[72:73], s[42:43]
    v_pk_mul_f32 v[74:75], v[74:75], s[42:43]
    v_cvt_pk_bf16_f32 v8, v72, v73
    v_cvt_pk_bf16_f32 v9, v74, v75
    v_pk_mul_f32 v[76:77], v[76:77], s[42:43]
    v_pk_mul_f32 v[78:79], v[78:79], s[42:43]
    v_cvt_pk_bf16_f32 v10, v76, v77
    v_cvt_pk_bf16_f32 v11, v78, v79
    v_pk_mul_f32 v[96:97], v[96:97], s[42:43]
    v_pk_mul_f32 v[98:99], v[98:99], s[42:43]
    v_cvt_pk_bf16_f32 v12, v96, v97
    v_cvt_pk_bf16_f32 v13, v98, v99
    v_pk_mul_f32 v[100:101], v[100:101], s[42:43]
    v_pk_mul_f32 v[102:103], v[102:103], s[42:43]
    v_cvt_pk_bf16_f32 v14, v100, v101
    v_cvt_pk_bf16_f32 v15, v102, v103
    v_pk_mul_f32 v[120:121], v[120:121], s[42:43]
    v_pk_mul_f32 v[122:123], v[122:123], s[42:43]
    v_cvt_pk_bf16_f32 v16, v120, v121
    v_cvt_pk_bf16_f32 v17, v122, v123
    v_pk_mul_f32 v[124:125], v[124:125], s[42:43]
    v_pk_mul_f32 v[126:127], v[126:127], s[42:43]
    v_cvt_pk_bf16_f32 v18, v124, v125
    v_cvt_pk_bf16_f32 v19, v126, v127
    v_pk_mul_f32 v[144:145], v[144:145], s[42:43]
    v_pk_mul_f32 v[146:147], v[146:147], s[42:43]
    v_cvt_pk_bf16_f32 v20, v144, v145
    v_cvt_pk_bf16_f32 v21, v146, v147
    v_pk_mul_f32 v[148:149], v[148:149], s[42:43]
    v_pk_mul_f32 v[150:151], v[150:151], s[42:43]
    v_cvt_pk_bf16_f32 v22, v148, v149
    v_cvt_pk_bf16_f32 v23, v150, v151
    v_mov_b32 v7, 0xff800000
    s_mov_b32 s40, 1431328085
    s_mov_b32 s41, 1342199040
    v_cndmask_b32 v64, v7, 0, s[40:41]
    s_mov_b32 s40, 2862656170
    s_mov_b32 s41, 2684398080
    v_cndmask_b32 v65, v7, 0, s[40:41]
    s_mov_b32 s40, 1430279508
    s_mov_b32 s41, 1073763328
    v_cndmask_b32 v66, v7, 0, s[40:41]
    s_mov_b32 s40, 2860559016
    s_mov_b32 s41, 2147526656
    v_cndmask_b32 v67, v7, 0, s[40:41]
    s_mov_b32 s40, 327680
    s_mov_b32 s41, 89456725
    v_cndmask_b32 v68, v7, 0, s[40:41]
    s_mov_b32 s40, 655360
    s_mov_b32 s41, 178913450
    v_cndmask_b32 v69, v7, 0, s[40:41]
    s_mov_b32 s40, 1376257
    s_mov_b32 s41, 357892437
    v_cndmask_b32 v70, v7, 0, s[40:41]
    s_mov_b32 s40, 2752514
    s_mov_b32 s41, 715784874
    v_cndmask_b32 v71, v7, 0, s[40:41]
    v_mov_b32 v2, 0x3f803f80
    v_mov_b32 v3, 0x3f803f80
    v_mov_b32 v4, 0x3f803f80
    v_mov_b32 v5, 0x3f803f80
    v_and_b32 v0, 0xf0, v1
    v_and_b32 v6, 0x300, v1
    v_lshl_add_u32 v0, v6, 1, v0
    v_mov_b64 v[116:117], v[68:69]
    v_mov_b64 v[118:119], v[70:71]
    s_waitcnt lgkmcnt(0)
    s_cmp_gt_u32 s19, 1
    s_cbranch_scc1 P1_b4
    v_mov_b32 v116, v7
    v_mov_b32 v117, v7
    v_mov_b32 v118, v7
    v_mov_b32 v119, v7
    v_mov_b64 v[24:25], 0
    v_mov_b64 v[26:27], 0
    v_mov_b64 v[44:45], 0
    v_mov_b64 v[54:55], 0
    s_mul_i32 s40, s19, 3072
    s_add_u32 s40, s40, 81920
    v_add_u32 v6, s40, v1
    ds_write_b128 v6, v[8:11]
    ds_write_b128 v6, v[28:31] offset:1024
    ds_write_b64 v6, v[46:47] offset:2048
    ds_write_b64 v6, v[56:57] offset:2056
P1_b4:
    s_and_b32 s38, s19, 6
    s_lshl_b32 s38, s38, 12
    s_lshl_b32 s39, s37, 11
    s_add_u32 s38, s38, s39
    s_add_u32 s38, s38, 114688
    v_add_u32 v6, s38, v0
    s_lshl_b32 s38, s17, 3
    s_and_b32 s39, s19, 6
    s_add_u32 s38, s38, s39
    s_lshl_b32 s38, s38, 5
    s_lshl_b32 s39, s18, 1
    s_add_u32 s38, s38, s39
    s_add_u32 s38, s38, s37
    s_lshl_b32 s38, s38, 11
    s_add_u32 s38, s38, 29360128
    s_add_u32 s39, s38, 65536
    v_mfma_f32_16x16x32_bf16 v[72:75], v[24:27], v[8:11], v[116:119]
    v_mfma_f32_16x16x32_bf16 v[76:79], v[28:31], v[8:11], v[64:67]
    v_mfma_f32_16x16x32_bf16 v[80:83], v[28:31], v[12:15], v[68:71]
    v_mfma_f32_16x16x32_bf16 v[84:87], v[32:35], v[12:15], v[64:67]
    v_mfma_f32_16x16x32_bf16 v[88:91], v[32:35], v[16:19], v[68:71]
    v_mfma_f32_16x16x32_bf16 v[92:95], v[36:39], v[16:19], v[64:67]
    v_mfma_f32_16x16x32_bf16 v[96:99], v[36:39], v[20:23], v[68:71]
    v_mfma_f32_16x16x32_bf16 v[100:103], v[40:43], v[20:23], v[64:67]
    s_nop 7
    v_max3_f32 v152, v72, v73, v74
    v_max3_f32 v156, v80, v81, v82
    v_max3_f32 v160, v88, v89, v90
    v_max3_f32 v164, v96, v97, v98
    v_max3_f32 v152, v75, v76, v152
    v_max3_f32 v156, v83, v84, v156
    v_max3_f32 v160, v91, v92, v160
    v_max3_f32 v164, v99, v100, v164
    v_max3_f32 v152, v77, v78, v152
    v_max3_f32 v156, v85, v86, v156
    v_max3_f32 v160, v93, v94, v160
    v_max3_f32 v164, v101, v102, v164
    v_max_f32 v152, v79, v152
    v_max_f32 v156, v87, v156
    v_max_f32 v160, v95, v160
    v_max_f32 v164, v103, v164
    v_mov_b32 v153, v152
    v_mov_b32 v157, v156
    v_mov_b32 v161, v160
    v_mov_b32 v165, v164
    v_permlane32_swap_b32 v152, v153
    v_permlane32_swap_b32 v156, v157
    v_permlane32_swap_b32 v160, v161
    v_permlane32_swap_b32 v164, v165
    v_max_f32 v152, v152, v153
    v_max_f32 v156, v156, v157
    v_max_f32 v160, v160, v161
    v_max_f32 v164, v164, v165
    v_mov_b32 v153, v152
    v_mov_b32 v157, v156
    v_mov_b32 v161, v160
    v_mov_b32 v165, v164
    v_permlane16_swap_b32 v152, v153
    v_permlane16_swap_b32 v156, v157
    v_permlane16_swap_b32 v160, v161
    v_permlane16_swap_b32 v164, v165
    v_max_f32 v152, v152, v153
    v_max_f32 v156, v156, v157
    v_max_f32 v160, v160, v161
    v_max_f32 v164, v164, v165
    v_pk_add_f32 v[72:73], v[72:73], v[152:153] op_sel_hi:[1,0] neg_lo:[0,1] neg_hi:[0,1]
    v_pk_add_f32 v[74:75], v[74:75], v[152:153] op_sel_hi:[1,0] neg_lo:[0,1] neg_hi:[0,1]
    v_pk_add_f32 v[76:77], v[76:77], v[152:153] op_sel_hi:[1,0] neg_lo:[0,1] neg_hi:[0,1]
    v_pk_add_f32 v[78:79], v[78:79], v[152:153] op_sel_hi:[1,0] neg_lo:[0,1] neg_hi:[0,1]
    v_pk_add_f32 v[80:81], v[80:81], v[156:157] op_sel_hi:[1,0] neg_lo:[0,1] neg_hi:[0,1]
    v_pk_add_f32 v[82:83], v[82:83], v[156:157] op_sel_hi:[1,0] neg_lo:[0,1] neg_hi:[0,1]
    v_pk_add_f32 v[84:85], v[84:85], v[156:157] op_sel_hi:[1,0] neg_lo:[0,1] neg_hi:[0,1]
    v_pk_add_f32 v[86:87], v[86:87], v[156:157] op_sel_hi:[1,0] neg_lo:[0,1] neg_hi:[0,1]
    v_pk_add_f32 v[88:89], v[88:89], v[160:161] op_sel_hi:[1,0] neg_lo:[0,1] neg_hi:[0,1]
    v_pk_add_f32 v[90:91], v[90:91], v[160:161] op_sel_hi:[1,0] neg_lo:[0,1] neg_hi:[0,1]
    v_pk_add_f32 v[92:93], v[92:93], v[160:161] op_sel_hi:[1,0] neg_lo:[0,1] neg_hi:[0,1]
    v_pk_add_f32 v[94:95], v[94:95], v[160:161] op_sel_hi:[1,0] neg_lo:[0,1] neg_hi:[0,1]
    v_pk_add_f32 v[96:97], v[96:97], v[164:165] op_sel_hi:[1,0] neg_lo:[0,1] neg_hi:[0,1]
    v_pk_add_f32 v[98:99], v[98:99], v[164:165] op_sel_hi:[1,0] neg_lo:[0,1] neg_hi:[0,1]
    v_pk_add_f32 v[100:101], v[100:101], v[164:165] op_sel_hi:[1,0] neg_lo:[0,1] neg_hi:[0,1]
    v_pk_add_f32 v[102:103], v[102:103], v[164:165] op_sel_hi:[1,0] neg_lo:[0,1] neg_hi:[0,1]
    v_exp_f32 v72, v72
    v_exp_f32 v73, v73
    v_exp_f32 v74, v74
    v_exp_f32 v75, v75
    v_exp_f32 v76, v76
    v_exp_f32 v77, v77
    v_exp_f32 v78, v78
    v_exp_f32 v79, v79
    v_exp_f32 v80, v80
    v_exp_f32 v81, v81
    v_exp_f32 v82, v82
    v_exp_f32 v83, v83
    v_exp_f32 v84, v84
    v_exp_f32 v85, v85
    v_exp_f32 v86, v86
    v_exp_f32 v87, v87
    v_exp_f32 v88, v88
    v_exp_f32 v89, v89
    v_exp_f32 v90, v90
    v_exp_f32 v91, v91
    v_exp_f32 v92, v92
    v_exp_f32 v93, v93
    v_exp_f32 v94, v94
    v_exp_f32 v95, v95
    v_exp_f32 v96, v96
    v_exp_f32 v97, v97
    v_exp_f32 v98, v98
    v_exp_f32 v99, v99
    v_exp_f32 v100, v100
    v_exp_f32 v101, v101
    v_exp_f32 v102, v102
    v_exp_f32 v103, v103
    s_nop 0
    v_cvt_pk_bf16_f32 v104, v72, v73
    v_cvt_pk_bf16_f32 v105, v74, v75
    v_cvt_pk_bf16_f32 v106, v76, v77
    v_cvt_pk_bf16_f32 v107, v78, v79
    v_cvt_pk_bf16_f32 v108, v80, v81
    v_cvt_pk_bf16_f32 v109, v82, v83
    v_cvt_pk_bf16_f32 v110, v84, v85
    v_cvt_pk_bf16_f32 v111, v86, v87
    v_cvt_pk_bf16_f32 v112, v88, v89
    v_cvt_pk_bf16_f32 v113, v90, v91
    v_cvt_pk_bf16_f32 v114, v92, v93
    v_cvt_pk_bf16_f32 v115, v94, v95
    v_cvt_pk_bf16_f32 v116, v96, v97
    v_cvt_pk_bf16_f32 v117, v98, v99
    v_cvt_pk_bf16_f32 v118, v100, v101
    v_cvt_pk_bf16_f32 v119, v102, v103
    s_nop 1
    v_mfma_f32_16x16x32_bf16 v[152:155], v[2:5], v[104:107], 0
    v_mfma_f32_16x16x32_bf16 v[120:123], v[44:47], v[104:107], 0
    v_mfma_f32_16x16x32_bf16 v[124:127], v[54:57], v[104:107], 0
    v_mfma_f32_16x16x32_bf16 v[156:159], v[2:5], v[108:111], 0
    v_mfma_f32_16x16x32_bf16 v[128:131], v[46:49], v[108:111], 0
    v_mfma_f32_16x16x32_bf16 v[132:135], v[56:59], v[108:111], 0
    v_mfma_f32_16x16x32_bf16 v[160:163], v[2:5], v[112:115], 0
    v_mfma_f32_16x16x32_bf16 v[136:139], v[48:51], v[112:115], 0
    v_mfma_f32_16x16x32_bf16 v[140:143], v[58:61], v[112:115], 0
    v_mfma_f32_16x16x32_bf16 v[164:167], v[2:5], v[116:119], 0
    v_mfma_f32_16x16x32_bf16 v[144:147], v[50:53], v[116:119], 0
    v_mfma_f32_16x16x32_bf16 v[148:151], v[60:63], v[116:119], 0
    s_nop 7
    v_rcp_f32 v152, v152
    v_rcp_f32 v156, v156
    v_rcp_f32 v160, v160
    v_rcp_f32 v164, v164
    s_nop 0
    v_pk_mul_f32 v[120:121], v[120:121], v[152:153] op_sel_hi:[1,0]
    v_pk_mul_f32 v[122:123], v[122:123], v[152:153] op_sel_hi:[1,0]
    v_pk_mul_f32 v[124:125], v[124:125], v[152:153] op_sel_hi:[1,0]
    v_pk_mul_f32 v[126:127], v[126:127], v[152:153] op_sel_hi:[1,0]
    v_cvt_pk_bf16_f32 v72, v120, v121
    v_cvt_pk_bf16_f32 v73, v122, v123
    v_cvt_pk_bf16_f32 v74, v124, v125
    v_cvt_pk_bf16_f32 v75, v126, v127
    buffer_store_dwordx4 v[72:75], v0, s[12:15], s38 offen offset:0 sc1
    v_pk_mul_f32 v[128:129], v[128:129], v[156:157] op_sel_hi:[1,0]
    v_pk_mul_f32 v[130:131], v[130:131], v[156:157] op_sel_hi:[1,0]
    v_pk_mul_f32 v[132:133], v[132:133], v[156:157] op_sel_hi:[1,0]
    v_pk_mul_f32 v[134:135], v[134:135], v[156:157] op_sel_hi:[1,0]
    v_cvt_pk_bf16_f32 v80, v128, v129
    v_cvt_pk_bf16_f32 v81, v130, v131
    v_cvt_pk_bf16_f32 v82, v132, v133
    v_cvt_pk_bf16_f32 v83, v134, v135
    buffer_store_dwordx4 v[80:83], v0, s[12:15], s38 offen offset:256 sc1
    v_pk_mul_f32 v[136:137], v[136:137], v[160:161] op_sel_hi:[1,0]
    v_pk_mul_f32 v[138:139], v[138:139], v[160:161] op_sel_hi:[1,0]
    v_pk_mul_f32 v[140:141], v[140:141], v[160:161] op_sel_hi:[1,0]
    v_pk_mul_f32 v[142:143], v[142:143], v[160:161] op_sel_hi:[1,0]
    v_cvt_pk_bf16_f32 v88, v136, v137
    v_cvt_pk_bf16_f32 v89, v138, v139
    v_cvt_pk_bf16_f32 v90, v140, v141
    v_cvt_pk_bf16_f32 v91, v142, v143
    buffer_store_dwordx4 v[88:91], v0, s[12:15], s39 offen offset:0 sc1
    v_pk_mul_f32 v[144:145], v[144:145], v[164:165] op_sel_hi:[1,0]
    v_pk_mul_f32 v[146:147], v[146:147], v[164:165] op_sel_hi:[1,0]
    v_pk_mul_f32 v[148:149], v[148:149], v[164:165] op_sel_hi:[1,0]
    v_pk_mul_f32 v[150:151], v[150:151], v[164:165] op_sel_hi:[1,0]
    v_cvt_pk_bf16_f32 v96, v144, v145
    v_cvt_pk_bf16_f32 v97, v146, v147
    v_cvt_pk_bf16_f32 v98, v148, v149
    v_cvt_pk_bf16_f32 v99, v150, v151
    buffer_store_dwordx4 v[96:99], v0, s[12:15], s39 offen offset:256 sc1
    s_waitcnt lgkmcnt(0)
    s_branch P2_compute
P2_fallback:
    s_mov_b32 s24, 1
    v_mov_b32 v28, 0xff800000
    v_mov_b32 v29, 0xff800000
    s_mov_b32 s21, 0
P2_maxloop:
    buffer_load_dwordx4 v[12:15], v31, s[4:7], s21 offen sc1
    buffer_load_dwordx4 v[16:19], v31, s[4:7], s21 offen offset:256 sc1
    s_waitcnt vmcnt(0)
    v_mfma_f32_32x32x16_bf16 v[32:47], v[12:15], v[64:67], 0
    v_mfma_f32_32x32x16_bf16 v[48:63], v[12:15], v[72:75], 0
    v_mfma_f32_32x32x16_bf16 v[32:47], v[16:19], v[68:71], v[32:47]
    v_mfma_f32_32x32x16_bf16 v[48:63], v[16:19], v[76:79], v[48:63]
    s_nop 7
    s_nop 3
    v_max3_f32 v28, v32, v33, v28
    v_max3_f32 v28, v34, v35, v28
    v_max3_f32 v28, v36, v37, v28
    v_max3_f32 v28, v38, v39, v28
    v_max3_f32 v28, v40, v41, v28
    v_max3_f32 v28, v42, v43, v28
    v_max3_f32 v28, v44, v45, v28
    v_max3_f32 v28, v46, v47, v28
    v_max3_f32 v29, v48, v49, v29
    v_max3_f32 v29, v50, v51, v29
    v_max3_f32 v29, v52, v53, v29
    v_max3_f32 v29, v54, v55, v29
    v_max3_f32 v29, v56, v57, v29
    v_max3_f32 v29, v58, v59, v29
    v_max3_f32 v29, v60, v61, v29
    v_max3_f32 v29, v62, v63, v29
    s_add_u32 s21, s21, 4096
    s_cmp_lt_u32 s21, 0x40000
    s_cbranch_scc1 P2_maxloop
    v_mov_b32 v6, v28
    s_nop 1
    v_permlane32_swap_b32 v28, v6
    s_nop 1
    v_max_f32 v28, v28, v6
    v_mov_b32 v6, v29
    s_nop 1
    v_permlane32_swap_b32 v29, v6
    s_nop 1
    v_max_f32 v29, v29, v6
    s_barrier
    s_branch P2_restart
P2_helpers:
    s_lshl_b32 s36, s18, 1
    s_add_u32 s16, s16, s36
    s_lshl_b32 s36, s16, 18
    s_add_u32 s36, s36, 4194304
    s_add_u32 s4, s92, s36
    s_addc_u32 s5, s93, 0
    s_mov_b32 s6, 0x40000
    s_mov_b32 s24, 0
    v_mov_b64 v[48:49], 0
    v_mov_b64 v[50:51], 0
    v_lshlrev_b32 v1, 4, v1
    s_lshl_b32 s26, s16, 6
    s_lshl_b32 s27, s17, 3
    s_add_u32 s26, s26, s27
    v_lshrrev_b32 v41, 4, v1
    v_lshrrev_b32 v42, 3, v41
    v_and_b32 v42, 1, v42
    s_lshl_b32 s40, s17, 1
    v_add_u32 v42, s40, v42
    v_lshrrev_b32 v40, 3, v42
    v_and_b32 v42, 7, v42
    v_lshl_add_u32 v40, v42, 3, v40
    v_and_b32 v42, 3, v41
    v_lshl_add_u32 v40, v42, 6, v40
    v_and_b32 v42, 4, v41
    v_lshrrev_b32 v42, 1, v42
    v_add3_u32 v40, v40, v42, 0
    v_lshlrev_b32 v40, 8, v40
    s_lshl_b32 s40, s16, 2
    s_add_u32 s40, s40, 33554560
    v_add_u32 v40, s40, v40
    s_cmp_eq_u32 s19, 9
    s_cbranch_scc1 P2_aux
    s_lshl_b32 s27, s26, 11
    s_barrier
    s_mov_b32 s47, 30000
    s_lshl_b32 s46, s2, 8
    s_add_u32 s46, s46, 33554432
    v_lshrrev_b32 v3, 2, v1
    v_and_b32 v3, 31, v3
P2_k_poll:
    buffer_load_dword v2, v3, s[12:15], s46 offen sc1
    s_sub_u32 s47, s47, 1
    s_waitcnt vmcnt(0)
    v_cmp_eq_u32 vcc, 0, v2
    s_cmp_eq_u32 s47, 0
    s_cbranch_scc1 P2_k_go
    s_cmp_eq_u64 vcc, 0
    s_cbranch_scc1 P2_k_go
    s_branch P2_k_poll
P2_k_go:
P2_lstart:
    s_cmp_eq_u32 s33, 0
    s_cbranch_scc1 P2_noq
    s_mov_b32 m0, 98304
    s_add_u32 s20, s27, 0
    buffer_load_dwordx4 v1, s[12:15], s20 offen offset:0 sc1 lds
    buffer_load_dwordx4 v1, s[12:15], s20 offen offset:1024 sc1 lds
    buffer_load_dwordx4 v1, s[12:15], s20 offen offset:2048 sc1 lds
    buffer_load_dwordx4 v1, s[12:15], s20 offen offset:3072 sc1 lds
    s_mov_b32 m0, 102400
    s_add_u32 s20, s27, 4096
    buffer_load_dwordx4 v1, s[12:15], s20 offen offset:0 sc1 lds
    buffer_load_dwordx4 v1, s[12:15], s20 offen offset:1024 sc1 lds
    buffer_load_dwordx4 v1, s[12:15], s20 offen offset:2048 sc1 lds
    buffer_load_dwordx4 v1, s[12:15], s20 offen offset:3072 sc1 lds
    s_mov_b32 m0, 106496
    s_add_u32 s20, s27, 8192
    buffer_load_dwordx4 v1, s[12:15], s20 offen offset:0 sc1 lds
    buffer_load_dwordx4 v1, s[12:15], s20 offen offset:1024 sc1 lds
    buffer_load_dwordx4 v1, s[12:15], s20 offen offset:2048 sc1 lds
    buffer_load_dwordx4 v1, s[12:15], s20 offen offset:3072 sc1 lds
    s_mov_b32 m0, 110592
    s_add_u32 s20, s27, 12288
    buffer_load_dwordx4 v1, s[12:15], s20 offen offset:0 sc1 lds
    buffer_load_dwordx4 v1, s[12:15], s20 offen offset:1024 sc1 lds
    buffer_load_dwordx4 v1, s[12:15], s20 offen offset:2048 sc1 lds
    buffer_load_dwordx4 v1, s[12:15], s20 offen offset:3072 sc1 lds
P2_noq:
    s_mov_b32 s21, 0
    s_mov_b32 s22, 0
    s_mov_b32 s23, 0
    s_call_b64 s[28:29], P2_lsub
    s_call_b64 s[28:29], P2_lsub
    s_waitcnt vmcnt(16)
    s_barrier
    s_call_b64 s[28:29], P2_lsub
    s_call_b64 s[28:29], P2_lsub
    s_waitcnt vmcnt(32)
    s_barrier
    s_waitcnt vmcnt(16)
    s_barrier
    s_mov_b32 s47, 30000
    s_lshl_b32 s46, s2, 8
    s_add_u32 s46, s46, 33554496
    v_lshrrev_b32 v3, 2, v1
    v_and_b32 v3, 31, v3
P2_k2_poll:
    buffer_load_dword v2, v3, s[12:15], s46 offen sc1
    s_sub_u32 s47, s47, 1
    s_waitcnt vmcnt(0)
    v_cmp_eq_u32 vcc, 0, v2
    s_cmp_eq_u32 s47, 0
    s_cbranch_scc1 P2_k2_go
    s_cmp_eq_u64 vcc, 0
    s_cbranch_scc1 P2_k2_go
    s_branch P2_k2_poll
P2_k2_go:
    s_call_b64 s[28:29], P2_lsub
    s_waitcnt vmcnt(16)
    s_barrier
    s_call_b64 s[28:29], P2_lsub
    s_call_b64 s[28:29], P2_lsub
    s_waitcnt vmcnt(32)
    s_barrier
    s_call_b64 s[28:29], P2_lsub
    s_waitcnt vmcnt(32)
    s_barrier
    s_waitcnt vmcnt(16)
    s_barrier
    s_mov_b32 s47, 30000
    s_lshl_b32 s46, s2, 8
    s_add_u32 s46, s46, 33554528
    v_lshrrev_b32 v3, 2, v1
    v_and_b32 v3, 31, v3
P2_k3_poll:
    buffer_load_dword v2, v3, s[12:15], s46 offen sc1
    s_sub_u32 s47, s47, 1
    s_waitcnt vmcnt(0)
    v_cmp_eq_u32 vcc, 0, v2
    s_cmp_eq_u32 s47, 0
    s_cbranch_scc1 P2_k3_go
    s_cmp_eq_u64 vcc, 0
    s_cbranch_scc1 P2_k3_go
    s_branch P2_k3_poll
P2_k3_go:
    s_call_b64 s[28:29], P2_lsub
    s_waitcnt vmcnt(16)
    s_barrier
    s_call_b64 s[28:29], P2_lsub
    s_call_b64 s[28:29], P2_lsub
    s_waitcnt vmcnt(32)
    s_barrier
    s_call_b64 s[28:29], P2_lsub
    s_call_b64 s[28:29], P2_lsub
    s_waitcnt vmcnt(48)
    s_barrier
    s_call_b64 s[28:29], P2_lsub
    s_waitcnt vmcnt(48)
    s_barrier
    s_call_b64 s[28:29], P2_lsub
    s_waitcnt vmcnt(48)
    s_barrier
    s_call_b64 s[28:29], P2_lsub
    s_waitcnt vmcnt(48)
    s_barrier
    s_waitcnt vmcnt(32)
    s_barrier
    s_waitcnt vmcnt(16)
    s_barrier
    s_waitcnt vmcnt(0)
    s_barrier
    s_waitcnt vmcnt(0)
    s_barrier
    s_branch P2_htail
P2_lsub:
    s_and_b32 s21, s23, 3
    s_lshl_b32 s21, s21, 15
    s_lshr_b32 s20, s23, 2
    s_lshl_b32 s20, s20, 13
    s_add_u32 s21, s21, s20
    s_add_u32 m0, s22, 0
    s_add_u32 s20, s21, 0
    buffer_load_dwordx4 v1, s[4:7], s20 offen offset:0 sc1 lds
    buffer_load_dwordx4 v1, s[4:7], s20 offen offset:1024 sc1 lds
    buffer_load_dwordx4 v1, s[4:7], s20 offen offset:2048 sc1 lds
    buffer_load_dwordx4 v1, s[4:7], s20 offen offset:3072 sc1 lds
    s_add_u32 m0, s22, 4096
    s_add_u32 s20, s21, 4096
    buffer_load_dwordx4 v1, s[4:7], s20 offen offset:0 sc1 lds
    buffer_load_dwordx4 v1, s[4:7], s20 offen offset:1024 sc1 lds
    buffer_load_dwordx4 v1, s[4:7], s20 offen offset:2048 sc1 lds
    buffer_load_dwordx4 v1, s[4:7], s20 offen offset:3072 sc1 lds
    s_add_u32 m0, s22, 8192
    s_add_u32 s20, s21, 131072
    buffer_load_dwordx4 v1, s[4:7], s20 offen offset:0 sc1 lds
    buffer_load_dwordx4 v1, s[4:7], s20 offen offset:1024 sc1 lds
    buffer_load_dwordx4 v1, s[4:7], s20 offen offset:2048 sc1 lds
    buffer_load_dwordx4 v1, s[4:7], s20 offen offset:3072 sc1 lds
    s_add_u32 m0, s22, 12288
    s_add_u32 s20, s21, 135168
    buffer_load_dwordx4 v1, s[4:7], s20 offen offset:0 sc1 lds
    buffer_load_dwordx4 v1, s[4:7], s20 offen offset:1024 sc1 lds
    buffer_load_dwordx4 v1, s[4:7], s20 offen offset:2048 sc1 lds
    buffer_load_dwordx4 v1, s[4:7], s20 offen offset:3072 sc1 lds
    s_add_u32 s22, s22, 16384
    s_cmp_eq_u32 s22, 98304
    s_cselect_b32 s22, 0, s22
    s_add_u32 s23, s23, 1
    s_setpc_b64 s[28:29]
P2_aux:
    v_readfirstlane_b32 s46, v23
    s_nop 3
    s_cmp_ge_u32 s46, 256
    s_cbranch_scc1 P2_c_go
    s_mov_b32 s47, 30000
P2_c_poll:
    buffer_load_dword v2, off, s[72:75], 0 sc1
    s_waitcnt vmcnt(0)
    v_readfirstlane_b32 s46, v2
    s_sub_u32 s47, s47, 1
    s_cmp_eq_u32 s47, 0
    s_cbranch_scc1 P2_c_go
    s_cmp_ge_u32 s46, 256
    s_cbranch_scc1 P2_c_go
    s_branch P2_c_poll
P2_c_go:
    s_barrier
    s_cmp_lg_u32 s33, 0
    s_cbranch_scc1 P2_auxb
    v_mov_b32 v2, 1
    s_mov_b64 exec, 65535
    buffer_store_dword v2, v10, s[12:15], 0 offen sc1
    s_mov_b64 exec, -1
    v_add_u32 v15, 114688, v1
    s_lshl_b32 s38, s31, 7
    s_lshl_b32 s39, s30, 3
    s_add_u32 s38, s38, s39
    s_lshl_b32 s38, s38, 12
    s_add_u32 s38, s38, 4202496
    s_barrier
    ds_read_b128 v[72:75], v15 offset:0
    ds_read_b128 v[76:79], v15 offset:1024
    ds_read_b128 v[80:83], v15 offset:2048
    ds_read_b128 v[84:87], v15 offset:3072
    ds_read_b128 v[88:91], v15 offset:4096
    ds_read_b128 v[92:95], v15 offset:5120
    ds_read_b128 v[96:99], v15 offset:6144
    ds_read_b128 v[100:103], v15 offset:7168
    s_add_u32 s39, s38, 0
    s_waitcnt lgkmcnt(7)
    buffer_store_dwordx4 v[72:75], v1, s[12:15], s39 offen offset:0 sc1
    s_waitcnt lgkmcnt(6)
    buffer_store_dwordx4 v[76:79], v1, s[12:15], s39 offen offset:1024 sc1
    s_waitcnt lgkmcnt(5)
    buffer_store_dwordx4 v[80:83], v1, s[12:15], s39 offen offset:2048 sc1
    s_waitcnt lgkmcnt(4)
    buffer_store_dwordx4 v[84:87], v1, s[12:15], s39 offen offset:3072 sc1
    s_add_u32 s39, s38, 4096
    s_waitcnt lgkmcnt(3)
    buffer_store_dwordx4 v[88:91], v1, s[12:15], s39 offen offset:0 sc1
    s_waitcnt lgkmcnt(2)
    buffer_store_dwordx4 v[92:95], v1, s[12:15], s39 offen offset:1024 sc1
    s_waitcnt lgkmcnt(1)
    buffer_store_dwordx4 v[96:99], v1, s[12:15], s39 offen offset:2048 sc1
    s_waitcnt lgkmcnt(0)
    buffer_store_dwordx4 v[100:103], v1, s[12:15], s39 offen offset:3072 sc1
    ds_read_b128 v[72:75], v15 offset:24576
    ds_read_b128 v[76:79], v15 offset:25600
    ds_read_b128 v[80:83], v15 offset:26624
    ds_read_b128 v[84:87], v15 offset:27648
    ds_read_b128 v[88:91], v15 offset:28672
    ds_read_b128 v[92:95], v15 offset:29696
    ds_read_b128 v[96:99], v15 offset:30720
    ds_read_b128 v[100:103], v15 offset:31744
    s_add_u32 s39, s38, 262144
    s_waitcnt lgkmcnt(7)
    buffer_store_dwordx4 v[72:75], v1, s[12:15], s39 offen offset:0 sc1
    s_waitcnt lgkmcnt(6)
    buffer_store_dwordx4 v[76:79], v1, s[12:15], s39 offen offset:1024 sc1
    s_waitcnt lgkmcnt(5)
    buffer_store_dwordx4 v[80:83], v1, s[12:15], s39 offen offset:2048 sc1
    s_waitcnt lgkmcnt(4)
    buffer_store_dwordx4 v[84:87], v1, s[12:15], s39 offen offset:3072 sc1
    s_add_u32 s39, s38, 266240
    s_waitcnt lgkmcnt(3)
    buffer_store_dwordx4 v[88:91], v1, s[12:15], s39 offen offset:0 sc1
    s_waitcnt lgkmcnt(2)
    buffer_store_dwordx4 v[92:95], v1, s[12:15], s39 offen offset:1024 sc1
    s_waitcnt lgkmcnt(1)
    buffer_store_dwordx4 v[96:99], v1, s[12:15], s39 offen offset:2048 sc1
    s_waitcnt lgkmcnt(0)
    buffer_store_dwordx4 v[100:103], v1, s[12:15], s39 offen offset:3072 sc1
    s_barrier
    v_add_u32 v10, 64, v10
    s_waitcnt vmcnt(0)
    v_mov_b32 v2, 1
    s_mov_b64 exec, 65535
    buffer_store_dword v2, v10, s[12:15], 0 offen sc1
    s_mov_b64 exec, -1
    s_barrier
    ds_read_b128 v[72:75], v15 offset:8192
    ds_read_b128 v[76:79], v15 offset:9216
    ds_read_b128 v[80:83], v15 offset:10240
    ds_read_b128 v[84:87], v15 offset:11264
    ds_read_b128 v[88:91], v15 offset:12288
    ds_read_b128 v[92:95], v15 offset:13312
    ds_read_b128 v[96:99], v15 offset:14336
    ds_read_b128 v[100:103], v15 offset:15360
    s_add_u32 s39, s38, 8192
    s_waitcnt lgkmcnt(7)
    buffer_store_dwordx4 v[72:75], v1, s[12:15], s39 offen offset:0 sc1
    s_waitcnt lgkmcnt(6)
    buffer_store_dwordx4 v[76:79], v1, s[12:15], s39 offen offset:1024 sc1
    s_waitcnt lgkmcnt(5)
    buffer_store_dwordx4 v[80:83], v1, s[12:15], s39 offen offset:2048 sc1
    s_waitcnt lgkmcnt(4)
    buffer_store_dwordx4 v[84:87], v1, s[12:15], s39 offen offset:3072 sc1
    s_add_u32 s39, s38, 12288
    s_waitcnt lgkmcnt(3)
    buffer_store_dwordx4 v[88:91], v1, s[12:15], s39 offen offset:0 sc1
    s_waitcnt lgkmcnt(2)
    buffer_store_dwordx4 v[92:95], v1, s[12:15], s39 offen offset:1024 sc1
    s_waitcnt lgkmcnt(1)
    buffer_store_dwordx4 v[96:99], v1, s[12:15], s39 offen offset:2048 sc1
    s_waitcnt lgkmcnt(0)
    buffer_store_dwordx4 v[100:103], v1, s[12:15], s39 offen offset:3072 sc1
    ds_read_b128 v[72:75], v15 offset:32768
    ds_read_b128 v[76:79], v15 offset:33792
    ds_read_b128 v[80:83], v15 offset:34816
    ds_read_b128 v[84:87], v15 offset:35840
    ds_read_b128 v[88:91], v15 offset:36864
    ds_read_b128 v[92:95], v15 offset:37888
    ds_read_b128 v[96:99], v15 offset:38912
    ds_read_b128 v[100:103], v15 offset:39936
    s_add_u32 s39, s38, 270336
    s_waitcnt lgkmcnt(7)
    buffer_store_dwordx4 v[72:75], v1, s[12:15], s39 offen offset:0 sc1
    s_waitcnt lgkmcnt(6)
    buffer_store_dwordx4 v[76:79], v1, s[12:15], s39 offen offset:1024 sc1
    s_waitcnt lgkmcnt(5)
    buffer_store_dwordx4 v[80:83], v1, s[12:15], s39 offen offset:2048 sc1
    s_waitcnt lgkmcnt(4)
    buffer_store_dwordx4 v[84:87], v1, s[12:15], s39 offen offset:3072 sc1
    s_add_u32 s39, s38, 274432
    s_waitcnt lgkmcnt(3)
    buffer_store_dwordx4 v[88:91], v1, s[12:15], s39 offen offset:0 sc1
    s_waitcnt lgkmcnt(2)
    buffer_store_dwordx4 v[92:95], v1, s[12:15], s39 offen offset:1024 sc1
    s_waitcnt lgkmcnt(1)
    buffer_store_dwordx4 v[96:99], v1, s[12:15], s39 offen offset:2048 sc1
    s_waitcnt lgkmcnt(0)
    buffer_store_dwordx4 v[100:103], v1, s[12:15], s39 offen offset:3072 sc1
    s_barrier
    ds_read_b128 v[72:75], v15 offset:16384
    ds_read_b128 v[76:79], v15 offset:17408
    ds_read_b128 v[80:83], v15 offset:18432
    ds_read_b128 v[84:87], v15 offset:19456
    ds_read_b128 v[88:91], v15 offset:20480
    ds_read_b128 v[92:95], v15 offset:21504
    ds_read_b128 v[96:99], v15 offset:22528
    ds_read_b128 v[100:103], v15 offset:23552
    s_add_u32 s39, s38, 16384
    s_waitcnt lgkmcnt(7)
    buffer_store_dwordx4 v[72:75], v1, s[12:15], s39 offen offset:0 sc1
    s_waitcnt lgkmcnt(6)
    buffer_store_dwordx4 v[76:79], v1, s[12:15], s39 offen offset:1024 sc1
    s_waitcnt lgkmcnt(5)
    buffer_store_dwordx4 v[80:83], v1, s[12:15], s39 offen offset:2048 sc1
    s_waitcnt lgkmcnt(4)
    buffer_store_dwordx4 v[84:87], v1, s[12:15], s39 offen offset:3072 sc1
    s_add_u32 s39, s38, 20480
    s_waitcnt lgkmcnt(3)
    buffer_store_dwordx4 v[88:91], v1, s[12:15], s39 offen offset:0 sc1
    s_waitcnt lgkmcnt(2)
    buffer_store_dwordx4 v[92:95], v1, s[12:15], s39 offen offset:1024 sc1
    s_waitcnt lgkmcnt(1)
    buffer_store_dwordx4 v[96:99], v1, s[12:15], s39 offen offset:2048 sc1
    s_waitcnt lgkmcnt(0)
    buffer_store_dwordx4 v[100:103], v1, s[12:15], s39 offen offset:3072 sc1
    ds_read_b128 v[72:75], v15 offset:40960
    ds_read_b128 v[76:79], v15 offset:41984
    ds_read_b128 v[80:83], v15 offset:43008
    ds_read_b128 v[84:87], v15 offset:44032
    ds_read_b128 v[88:91], v15 offset:45056
    ds_read_b128 v[92:95], v15 offset:46080
    ds_read_b128 v[96:99], v15 offset:47104
    ds_read_b128 v[100:103], v15 offset:48128
    s_add_u32 s39, s38, 278528
    s_waitcnt lgkmcnt(7)
    buffer_store_dwordx4 v[72:75], v1, s[12:15], s39 offen offset:0 sc1
    s_waitcnt lgkmcnt(6)
    buffer_store_dwordx4 v[76:79], v1, s[12:15], s39 offen offset:1024 sc1
    s_waitcnt lgkmcnt(5)
    buffer_store_dwordx4 v[80:83], v1, s[12:15], s39 offen offset:2048 sc1
    s_waitcnt lgkmcnt(4)
    buffer_store_dwordx4 v[84:87], v1, s[12:15], s39 offen offset:3072 sc1
    s_add_u32 s39, s38, 282624
    s_waitcnt lgkmcnt(3)
    buffer_store_dwordx4 v[88:91], v1, s[12:15], s39 offen offset:0 sc1
    s_waitcnt lgkmcnt(2)
    buffer_store_dwordx4 v[92:95], v1, s[12:15], s39 offen offset:1024 sc1
    s_waitcnt lgkmcnt(1)
    buffer_store_dwordx4 v[96:99], v1, s[12:15], s39 offen offset:2048 sc1
    s_waitcnt lgkmcnt(0)
    buffer_store_dwordx4 v[100:103], v1, s[12:15], s39 offen offset:3072 sc1
    s_barrier
    s_barrier
    v_add_u32 v10, 32, v10
    s_waitcnt vmcnt(0)
    v_mov_b32 v2, 1
    s_mov_b64 exec, 65535
    buffer_store_dword v2, v10, s[12:15], 0 offen sc1
    s_mov_b64 exec, -1
    s_branch P2_a1
P2_auxb:
    s_add_u32 s38, s30, 1
    s_lshr_b32 s39, s38, 2
    s_and_b32 s38, s38, 3
    s_lshl_b32 s38, s38, 3
    s_add_u32 s38, s38, s39
    s_and_b32 s39, s2, -26
    s_add_u32 s38, s38, s39
    s_lshl_b32 s38, s38, 8
    s_add_u32 s38, s38, 33554464
    v_mov_b32 v14, s38
    s_barrier
    v_add_u32 v6, 81920, v1
    ds_read_b128 v[120:123], v6 offset:0
    ds_read_b128 v[128:131], v6 offset:1024
    ds_read_b64 v[134:135], v6 offset:2048
    ds_read_b64 v[138:139], v6 offset:2056
    ds_read_b128 v[144:147], v6 offset:3072
    ds_read_b128 v[152:155], v6 offset:4096
    ds_read_b64 v[158:159], v6 offset:5120
    ds_read_b64 v[162:163], v6 offset:5128
    s_lshl_b32 s38, s30, 8
    s_lshl_b32 s39, s31, 1
    s_add_u32 s38, s38, s39
    s_lshl_b32 s38, s38, 11
    s_add_u32 s38, s38, 29360128
    v_add_u32 v15, 114688, v1
    s_waitcnt lgkmcnt(0)
    s_barrier
    s_cmp_eq_u32 s30, 7
    s_cbranch_scc1 P2_auxb1
    v_mov_b32 v2, 1
    s_mov_b64 exec, 1
    buffer_store_dword v2, v14, s[12:15], 0 offen sc1
    s_mov_b64 exec, -1
P2_auxb1:
    s_barrier
    s_barrier
    s_cmp_eq_u32 s30, 0
    s_cbranch_scc1 P2_auxb2
    s_mov_b32 s47, 30000
    s_lshl_b32 s46, s2, 8
    s_add_u32 s46, s46, 33554464
    v_lshrrev_b32 v5, 2, v1
    v_and_b32 v5, 3, v5
P2_h_poll:
    buffer_load_dword v4, v5, s[12:15], s46 offen sc1
    s_sub_u32 s47, s47, 1
    s_waitcnt vmcnt(0)
    v_cmp_eq_u32 vcc, 0, v4
    s_cmp_eq_u32 s47, 0
    s_cbranch_scc1 P2_h_go
    s_cmp_eq_u64 vcc, 0
    s_cbranch_scc1 P2_h_go
    s_branch P2_h_poll
P2_h_go:
    s_lshl_b32 s36, s31, 3
    s_add_u32 s36, s36, s30
    s_lshl_b32 s36, s36, 12
    s_add_u32 s36, s36, 12578816
    buffer_load_dwordx4 v[124:127], v1, s[12:15], s36 offen offset:0 sc1
    buffer_load_dwordx2 v[132:133], v1, s[12:15], s36 offen offset:1024 sc1
    buffer_load_dwordx2 v[136:137], v1, s[12:15], s36 offen offset:1032 sc1
    buffer_load_dwordx4 v[148:151], v1, s[12:15], s36 offen offset:2048 sc1
    buffer_load_dwordx2 v[156:157], v1, s[12:15], s36 offen offset:3072 sc1
    buffer_load_dwordx2 v[160:161], v1, s[12:15], s36 offen offset:3080 sc1
    v_mov_b32 v7, 0xff800000
    s_mov_b32 s40, 1431328085
    s_mov_b32 s41, 1342199040
    v_cndmask_b32 v64, v7, 0, s[40:41]
    s_mov_b32 s40, 2862656170
    s_mov_b32 s41, 2684398080
    v_cndmask_b32 v65, v7, 0, s[40:41]
    s_mov_b32 s40, 1430279508
    s_mov_b32 s41, 1073763328
    v_cndmask_b32 v66, v7, 0, s[40:41]
    s_mov_b32 s40, 2860559016
    s_mov_b32 s41, 2147526656
    v_cndmask_b32 v67, v7, 0, s[40:41]
    s_mov_b32 s40, 327680
    s_mov_b32 s41, 89456725
    v_cndmask_b32 v68, v7, 0, s[40:41]
    s_mov_b32 s40, 655360
    s_mov_b32 s41, 178913450
    v_cndmask_b32 v69, v7, 0, s[40:41]
    s_mov_b32 s40, 1376257
    s_mov_b32 s41, 357892437
    v_cndmask_b32 v70, v7, 0, s[40:41]
    s_mov_b32 s40, 2752514
    s_mov_b32 s41, 715784874
    v_cndmask_b32 v71, v7, 0, s[40:41]
    v_mov_b32 v2, 0x3f803f80
    v_mov_b32 v3, 0x3f803f80
    v_mov_b32 v4, 0x3f803f80
    v_mov_b32 v5, 0x3f803f80
    v_and_b32 v0, 0xf0, v1
    v_and_b32 v6, 0x300, v1
    v_lshl_add_u32 v0, v6, 1, v0
    s_barrier
    s_waitcnt vmcnt(0) lgkmcnt(0)
    s_setprio 3
    v_mfma_f32_16x16x32_bf16 v[72:75], v[124:127], v[120:123], v[68:71]
    v_mfma_f32_16x16x32_bf16 v[76:79], v[128:131], v[120:123], v[64:67]
    v_mfma_f32_16x16x32_bf16 v[80:83], v[148:151], v[144:147], v[68:71]
    v_mfma_f32_16x16x32_bf16 v[84:87], v[152:155], v[144:147], v[64:67]
    s_nop 7
    v_max3_f32 v112, v72, v73, v74
    v_max3_f32 v116, v80, v81, v82
    v_max3_f32 v112, v75, v76, v112
    v_max3_f32 v116, v83, v84, v116
    v_max3_f32 v112, v77, v78, v112
    v_max3_f32 v116, v85, v86, v116
    v_max_f32 v112, v79, v112
    v_max_f32 v116, v87, v116
    v_mov_b32 v113, v112
    v_mov_b32 v117, v116
    s_nop 0
    v_permlane32_swap_b32 v112, v113
    v_permlane32_swap_b32 v116, v117
    s_nop 0
    v_max_f32 v112, v112, v113
    v_max_f32 v116, v116, v117
    v_mov_b32 v113, v112
    v_mov_b32 v117, v116
    s_nop 0
    v_permlane16_swap_b32 v112, v113
    v_permlane16_swap_b32 v116, v117
    s_nop 0
    v_max_f32 v112, v112, v113
    v_max_f32 v116, v116, v117
    v_pk_add_f32 v[72:73], v[72:73], v[112:113] op_sel_hi:[1,0] neg_lo:[0,1] neg_hi:[0,1]
    v_pk_add_f32 v[74:75], v[74:75], v[112:113] op_sel_hi:[1,0] neg_lo:[0,1] neg_hi:[0,1]
    v_pk_add_f32 v[76:77], v[76:77], v[112:113] op_sel_hi:[1,0] neg_lo:[0,1] neg_hi:[0,1]
    v_pk_add_f32 v[78:79], v[78:79], v[112:113] op_sel_hi:[1,0] neg_lo:[0,1] neg_hi:[0,1]
    v_pk_add_f32 v[80:81], v[80:81], v[116:117] op_sel_hi:[1,0] neg_lo:[0,1] neg_hi:[0,1]
    v_pk_add_f32 v[82:83], v[82:83], v[116:117] op_sel_hi:[1,0] neg_lo:[0,1] neg_hi:[0,1]
    v_pk_add_f32 v[84:85], v[84:85], v[116:117] op_sel_hi:[1,0] neg_lo:[0,1] neg_hi:[0,1]
    v_pk_add_f32 v[86:87], v[86:87], v[116:117] op_sel_hi:[1,0] neg_lo:[0,1] neg_hi:[0,1]
    v_exp_f32 v72, v72
    v_exp_f32 v73, v73
    v_exp_f32 v74, v74
    v_exp_f32 v75, v75
    v_exp_f32 v76, v76
    v_exp_f32 v77, v77
    v_exp_f32 v78, v78
    v_exp_f32 v79, v79
    v_exp_f32 v80, v80
    v_exp_f32 v81, v81
    v_exp_f32 v82, v82
    v_exp_f32 v83, v83
    v_exp_f32 v84, v84
    v_exp_f32 v85, v85
    v_exp_f32 v86, v86
    v_exp_f32 v87, v87
    s_nop 0
    v_cvt_pk_bf16_f32 v88, v72, v73
    v_cvt_pk_bf16_f32 v89, v74, v75
    v_cvt_pk_bf16_f32 v90, v76, v77
    v_cvt_pk_bf16_f32 v91, v78, v79
    v_cvt_pk_bf16_f32 v92, v80, v81
    v_cvt_pk_bf16_f32 v93, v82, v83
    v_cvt_pk_bf16_f32 v94, v84, v85
    v_cvt_pk_bf16_f32 v95, v86, v87
    s_nop 1
    v_mfma_f32_16x16x32_bf16 v[112:115], v[2:5], v[88:91], 0
    v_mfma_f32_16x16x32_bf16 v[96:99], v[132:135], v[88:91], 0
    v_mfma_f32_16x16x32_bf16 v[100:103], v[136:139], v[88:91], 0
    v_mfma_f32_16x16x32_bf16 v[116:119], v[2:5], v[92:95], 0
    v_mfma_f32_16x16x32_bf16 v[104:107], v[156:159], v[92:95], 0
    v_mfma_f32_16x16x32_bf16 v[108:111], v[160:163], v[92:95], 0
    s_nop 7
    v_rcp_f32 v112, v112
    v_rcp_f32 v116, v116
    s_nop 0
    v_pk_mul_f32 v[96:97], v[96:97], v[112:113] op_sel_hi:[1,0]
    v_pk_mul_f32 v[98:99], v[98:99], v[112:113] op_sel_hi:[1,0]
    v_pk_mul_f32 v[100:101], v[100:101], v[112:113] op_sel_hi:[1,0]
    v_pk_mul_f32 v[102:103], v[102:103], v[112:113] op_sel_hi:[1,0]
    v_cvt_pk_bf16_f32 v72, v96, v97
    v_cvt_pk_bf16_f32 v73, v98, v99
    v_cvt_pk_bf16_f32 v74, v100, v101
    v_cvt_pk_bf16_f32 v75, v102, v103
    buffer_store_dwordx4 v[72:75], v0, s[12:15], s38 offen offset:0 sc1
    v_pk_mul_f32 v[104:105], v[104:105], v[116:117] op_sel_hi:[1,0]
    v_pk_mul_f32 v[106:107], v[106:107], v[116:117] op_sel_hi:[1,0]
    v_pk_mul_f32 v[108:109], v[108:109], v[116:117] op_sel_hi:[1,0]
    v_pk_mul_f32 v[110:111], v[110:111], v[116:117] op_sel_hi:[1,0]
    v_cvt_pk_bf16_f32 v80, v104, v105
    v_cvt_pk_bf16_f32 v81, v106, v107
    v_cvt_pk_bf16_f32 v82, v108, v109
    v_cvt_pk_bf16_f32 v83, v110, v111
    buffer_store_dwordx4 v[80:83], v0, s[12:15], s38 offen offset:2048 sc1
    s_setprio 3
    s_barrier
    s_branch P2_a1
P2_auxb2:
    s_barrier
    s_barrier
    s_branch P2_a1
P2_astart:
    s_barrier
    s_barrier
    s_barrier
    s_barrier
    s_barrier
    s_barrier
P2_a1:
    s_mov_b32 s10, 0x200000
    s_cmp_lt_u32 s34, 4
    s_cselect_b32 s8, s80, s86
    s_cselect_b32 s9, s81, s87
    v_and_b32 v44, 0x70, v1
    v_lshlrev_b32 v44, 3, v44
    v_lshrrev_b32 v45, 7, v1
    v_lshl_add_u32 v44, v45, 11, v44
    s_lshl_b32 s40, s35, 16
    s_and_b32 s41, s34, 2
    s_lshl_b32 s41, s41, 9
    s_add_u32 s40, s40, s41
    buffer_load_dword v46, v44, s[8:11], s40 offen
    s_add_u32 s40, s40, 16384
    buffer_load_dword v46, v44, s[8:11], s40 offen
    s_add_u32 s40, s40, 16384
    s_barrier
    buffer_load_dword v46, v44, s[8:11], s40 offen
    s_add_u32 s40, s40, 16384
    s_barrier
    buffer_load_dword v46, v44, s[8:11], s40 offen
    s_add_u32 s40, s40, 16384
    s_barrier
    s_cmp_eq_u32 s33, 0
    s_cbranch_scc1 P2_a2
    s_waitcnt vmcnt(0)
    v_mov_b32 v2, 1
    s_mov_b64 exec, 4294967295
    buffer_store_dword v2, v12, s[12:15], 0 offen sc1
    s_mov_b64 exec, -1
    s_mov_b32 s33, 0
P2_a2:
    s_lshr_b32 s16, s34, 2
    s_and_b32 s17, s34, 1
    s_lshl_b32 s17, s17, 3
    s_and_b32 s36, s35, 7
    s_add_u32 s17, s17, s36
    s_lshr_b32 s18, s34, 1
    s_and_b32 s18, s18, 1
    s_lshl_b32 s18, s18, 2
    s_lshr_b32 s36, s35, 3
    s_add_u32 s18, s18, s36
    v_lshrrev_b32 v52, 4, v1
    s_lshl_b32 s39, s18, 8
    s_sub_u32 s6, 2097152, s39
    v_lshrrev_b32 v53, 4, v52
    v_lshlrev_b32 v54, 1, v53
    v_and_b32 v55, 15, v52
    v_xor_b32 v54, v54, v55
    v_lshlrev_b32 v54, 4, v54
    v_lshl_add_u32 v48, v53, 11, v54
    v_xor_b32 v49, 128, v48
    v_add_u32 v49, 7168, v49
    s_lshl_b32 s40, 16384, s16
    s_sub_u32 s40, s40, 2048
    s_lshr_b32 s41, 32768, s16
    s_cmp_eq_u32 s16, 0
    v_add_u32 v50, s40, v48
    v_add_u32 v51, s40, v49
    s_cselect_b32 s4, s80, s86
    s_cselect_b32 s5, s81, s87
    s_add_u32 s4, s4, s39
    s_addc_u32 s5, s5, 0
    s_lshl_b32 s21, s34, 18
    s_mov_b32 s23, 98304
    s_mov_b32 s38, 0
P3_w_go2:
    s_add_u32 m0, s23, 0
    s_add_u32 s20, s21, 0
    buffer_load_dwordx4 v48, s[4:7], s20 offen offset:0 lds
    buffer_load_dwordx4 v49, s[4:7], s20 offen offset:1024 lds
    buffer_load_dwordx4 v50, s[4:7], s20 offen offset:2048 lds
    buffer_load_dwordx4 v51, s[4:7], s20 offen offset:3072 lds
    s_add_u32 m0, s23, 4096
    s_add_u32 s20, s20, s41
    buffer_load_dwordx4 v48, s[4:7], s20 offen offset:0 lds
    buffer_load_dwordx4 v49, s[4:7], s20 offen offset:1024 lds
    buffer_load_dwordx4 v50, s[4:7], s20 offen offset:2048 lds
    buffer_load_dwordx4 v51, s[4:7], s20 offen offset:3072 lds
    s_add_u32 m0, s23, 8192
    s_add_u32 s20, s21, 65536
    buffer_load_dwordx4 v48, s[4:7], s20 offen offset:0 lds
    buffer_load_dwordx4 v49, s[4:7], s20 offen offset:1024 lds
    buffer_load_dwordx4 v50, s[4:7], s20 offen offset:2048 lds
    buffer_load_dwordx4 v51, s[4:7], s20 offen offset:3072 lds
    s_add_u32 m0, s23, 12288
    s_add_u32 s20, s20, s41
    buffer_load_dwordx4 v48, s[4:7], s20 offen offset:0 lds
    buffer_load_dwordx4 v49, s[4:7], s20 offen offset:1024 lds
    buffer_load_dwordx4 v50, s[4:7], s20 offen offset:2048 lds
    buffer_load_dwordx4 v51, s[4:7], s20 offen offset:3072 lds
    s_add_u32 s21, s21, 0x20000
    s_and_b32 s21, s21, 0x1fffff
    s_add_u32 s38, s38, 1
    s_add_u32 s23, s23, 16384
    s_cmp_eq_u32 s23, 163840
    s_cselect_b32 s23, 65536, s23
    s_cmp_le_u32 s38, 6
    s_cbranch_scc1 P2_wback
P3_w_l1:
    s_waitcnt vmcnt(63)
    s_barrier
    s_cmp_lt_u32 s38, 16
    s_cbranch_scc1 P3_w_go2
    s_waitcnt vmcnt(48)
    s_barrier
    s_waitcnt vmcnt(32)
    s_barrier
    s_waitcnt vmcnt(16)
    s_barrier
    s_waitcnt vmcnt(0)
    s_barrier
    s_endpgm
P2_wback:
    s_barrier
    s_cmp_lg_u32 s38, 4
    s_cbranch_scc1 P2_wb1
    s_barrier
P2_wb1:
    s_cmp_lt_u32 s38, 6
    s_cbranch_scc1 P3_w_go2
    s_barrier
P2_htail:
    s_barrier
    s_cmp_lg_u32 s24, 0
    s_cbranch_scc1 P2_hfin
    v_mov_b32 v7, 40960
    ds_read_b128 v[8:11], v7
    ds_read_b128 v[12:15], v7 offset:16
    s_waitcnt lgkmcnt(0)
    v_or3_b32 v8, v8, v12, v13
    v_or3_b32 v8, v8, v14, v15
    v_or3_b32 v8, v8, v9, v10
    v_or_b32 v8, v8, v11
    s_nop 0
    v_readfirstlane_b32 s44, v8
    s_nop 3
    s_cmp_eq_u32 s44, 0
    s_cbranch_scc1 P2_hfin
    s_mov_b32 s24, 1
    s_waitcnt vmcnt(0)
    s_barrier
    s_cmp_eq_u32 s19, 9
    s_cbranch_scc1 P2_astart
    s_branch P2_lstart
P2_hfin:
    s_cmp_eq_u32 s19, 9
    s_cbranch_scc0 P3_oload
    s_barrier
    s_waitcnt vmcnt(0)
    s_barrier
    s_branch P3_w_l1
L_done:
    s_endpgm
.section .rodata,"a"
.p2align 6
.amdhsa_kernel concat_heads__mha_block__sliding_local_dilated__prompt_kernel
  .amdhsa_next_free_vgpr 168
  .amdhsa_next_free_sgpr 102
  .amdhsa_accum_offset 168
  .amdhsa_group_segment_fixed_size 0
  .amdhsa_kernarg_size 72
  .amdhsa_user_sgpr_count 2
  .amdhsa_user_sgpr_kernarg_segment_ptr 1
  .amdhsa_system_sgpr_workgroup_id_x 1
.end_amdhsa_kernel
```
